```python
import torch

def _softmax(x, axis=-1):
    return torch.softmax(x, dim=axis)
def _gelu(x):
    return torch.nn.functional.gelu(x, approximate="tanh")
def _silu(x):
    return torch.nn.functional.silu(x)
def _sigmoid(x):
    return torch.sigmoid(x)
def _layernorm(x, axis=-1, eps=1e-5):
    m = x.mean(dim=axis, keepdim=True)
    v = x.var(dim=axis, keepdim=True, unbiased=False)
    return (x - m) / torch.sqrt(v + eps)
def _scatter_add(tgt, idx, src, axis=0):
    return tgt.clone().index_add_(axis, idx, src)
def _segment_sum(src, seg, n):
    out = torch.zeros((n,) + src.shape[1:], dtype=src.dtype)
    return out.index_add_(0, seg, src)
def _pad(x, pw):
    flat = tuple(v for pair in reversed(pw) for v in pair)
    return torch.nn.functional.pad(x, flat)

kernel_name = 'parallel_sum__sliding_block_cached__glu_gated_swiglu__decode'

def setup_inputs():

    _w = (lambda a: (lambda t: t.to(torch.bfloat16) if t.is_floating_point() else t)(torch.as_tensor(a)))
    def _A_setup():
        B, Sq, D = 2, 1, 512
        Hq, Hkv, Sk, Dh = 32, 32, 16384, 128
        assert Hq % Hkv == 0, (Hq, Hkv)
        return {
            "x": _w((lambda *s: torch.randn(*s, dtype=torch.bfloat16) * 0.05)(B, Sq, D)),
            "k_cache": _w((lambda *s: torch.randn(*s, dtype=torch.bfloat16) * 1.6)(B, Hkv, Sk, Dh)),
            "v_cache": _w((lambda *s: torch.randn(*s, dtype=torch.bfloat16) * 0.8)(B, Hkv, Sk, Dh)),
            "wq": _w((lambda *s: torch.randn(*s, dtype=torch.bfloat16) * 1.6)(D, Hq * Dh) * (D ** -0.5)),
            "wo": _w((lambda *s: torch.randn(*s, dtype=torch.bfloat16) * 0.8)(Hq * Dh, D) * ((Hq * Dh) ** -0.5)),
        }
    _A_in = _A_setup()

    def _B_setup():
        B, S, D, F = 2, 1, 512, 1376
        return {
            "x": _w((lambda *s: torch.randn(*s, dtype=torch.bfloat16) * 0.05)(B, S, D)),
            "w1": _w((lambda *s: torch.randn(*s, dtype=torch.bfloat16) * 0.4)(D, F) * (2.0 / D) ** 0.5),
            "w3": _w((lambda *s: torch.randn(*s, dtype=torch.bfloat16) * 0.4)(D, F) * (2.0 / D) ** 0.5),
            "w2": _w((lambda *s: torch.randn(*s, dtype=torch.bfloat16) * 0.4)(F, D) * (2.0 / F) ** 0.5),
        }
    _B_in = _B_setup()

    return {
        "A_x": _A_in["x"],
        "A_k_cache": _A_in["k_cache"],
        "A_v_cache": _A_in["v_cache"],
        "A_wq": _A_in["wq"],
        "A_wo": _A_in["wo"],
        "B_x": _B_in["x"],
        "B_w1": _B_in["w1"],
        "B_w3": _B_in["w3"],
        "B_w2": _B_in["w2"],
    }

def reference(A_x, A_k_cache, A_v_cache, A_wq, A_wo, B_x, B_w1, B_w3, B_w2):
    def _A_ref(x, k_cache, v_cache, wq, wo):
        B, Sq, D = x.shape
        Hq, Dh = 32, 128
        Hkv, Sk = k_cache.shape[1], k_cache.shape[2]
        W = min(4096, max(256, Sk // 4))
        rep = Hq // Hkv
        q = (lambda x, *d: x.permute(*d))((x @ wq).reshape(B, Sq, Hq, Dh), 0, 2, 1, 3)
        k = (lambda x, n, axis: torch.repeat_interleave(x, n, dim=axis))(k_cache[:, :, Sk - W:, :], rep, axis=1)
        v = (lambda x, n, axis: torch.repeat_interleave(x, n, dim=axis))(v_cache[:, :, Sk - W:, :], rep, axis=1)
        scores = torch.einsum("bhqd,bhkd->bhqk", q, k) * (Dh ** -0.5)
        p = _softmax(scores, axis=-1)
        o = torch.einsum("bhqk,bhkd->bhqd", p, v)
        return (lambda x, *d: x.permute(*d))(o, 0, 2, 1, 3).reshape(B, Sq, Hq * Dh) @ wo

    def _B_ref(x, w1, w3, w2):
        gate = torch.einsum("bsd,df->bsf", x, w1)
        up = torch.einsum("bsd,df->bsf", x, w3)
        h = _silu(gate) * up
        out = torch.einsum("bsf,fd->bsd", h, w2)
        return out

    x = A_x
    xn = _layernorm(x, axis=-1)
    return x + _A_ref(xn, A_k_cache, A_v_cache, A_wq, A_wo) + _B_ref(xn, B_w1, B_w3, B_w2)
```

```asm
; @launch grid=(256,1,1) block=(256,1,1) lds=10240
.amdgcn_target "amdgcn-amd-amdhsa--gfx950"
.text
.globl parallel_sum__sliding_block_cached__glu_gated_swiglu__decode_kernel
.p2align 8
.type parallel_sum__sliding_block_cached__glu_gated_swiglu__decode_kernel,@function
parallel_sum__sliding_block_cached__glu_gated_swiglu__decode_kernel:
    s_load_dwordx16 s[4:19], s[0:1], 0
    s_load_dwordx8 s[20:27], s[0:1], 64
    s_cmp_ge_u32 s2, 256
    s_cbranch_scc1 L_end
    s_and_b32 s68, s2, 7
    s_lshr_b32 s69, s2, 3
    s_lshr_b32 s70, s2, 6
    s_lshl2_add_u32 s71, s68, s70
    s_bfe_u32 s72, s2, 0x10005
    s_and_b32 s73, s69, 3
    s_lshl_b32 s75, s72, 5
    s_add_u32 s75, s75, s71
    s_lshl4_add_u32 s78, s75, s73
    s_add_u32 s78, s78, 12
    s_lshl_b32 s78, s78, 18
    s_mul_i32 s81, s2, 12288
    s_mov_b32 s83, 0x3ffff
    s_and_b32 s81, s81, s83
    v_lshlrev_b32 v1, 4, v0
    s_mov_b32 s30, 0x40000
    s_mov_b32 s31, 0x20000
    v_lshrrev_b32 v2, 6, v0
    v_and_b32 v15, 63, v0
    s_mov_b32 s82, s81
    v_readfirstlane_b32 s3, v2
    s_getpc_b64 s[64:65]
L_pc:
    s_mov_b32 s66, L_codeend - L_pc
    s_mov_b32 s67, 0x20000
    s_lshl_b32 s79, s69, 10
    v_lshl_add_u32 v30, v0, 2, s79
    buffer_load_dword v47, v30, s[64:67], 0 offen
    s_waitcnt lgkmcnt(0)
    s_add_u32 s28, s6, s78
    s_addc_u32 s29, s7, 0
    buffer_load_dwordx4 v[48:51], v1, s[28:31], s81 offen nt
    s_addk_i32 s81, 0x1000
    s_and_b32 s81, s81, s83
    buffer_load_dwordx4 v[52:55], v1, s[28:31], s81 offen nt
    s_addk_i32 s81, 0x1000
    s_and_b32 s81, s81, s83
    buffer_load_dwordx4 v[56:59], v1, s[28:31], s81 offen nt
    s_addk_i32 s81, 0x1000
    s_and_b32 s81, s81, s83
    buffer_load_dwordx4 v[60:63], v1, s[28:31], s81 offen nt
    s_addk_i32 s81, 0x1000
    s_and_b32 s81, s81, s83
    s_load_dword s0, s[26:27], 802816
    s_add_u32 s32, s8, s78
    s_addc_u32 s33, s9, 0
    s_mov_b32 s52, s4
    s_mov_b32 s53, s5
    s_mov_b32 s54, 2048
    s_mov_b32 s55, 0x20000
    v_lshlrev_b32 v30, 5, v15
    buffer_load_dwordx4 v[208:211], v30, s[52:55], 0 offen
    buffer_load_dwordx4 v[212:215], v30, s[52:55], 0 offen offset:16
    s_and_b32 s74, s69, 7
    v_lshrrev_b32 v28, 4, v15
    v_and_b32 v29, 15, v15
    s_lshl_b32 s79, s74, 19
    s_lshl_b32 s80, s71, 8
    s_add_u32 s79, s79, s80
    s_add_u32 s36, s10, s79
    s_addc_u32 s37, s11, 0
    s_mov_b32 s38, 516352
    s_mov_b32 s39, 0x20000
    v_lshrrev_b32 v31, 4, v0
    v_and_b32 v32, 12, v31
    v_lshl_add_u32 v31, v32, 2, v28
    v_lshlrev_b32 v31, 13, v31
    v_lshl_add_u32 v35, v29, 4, v31
    buffer_load_dwordx4 a[192:195], v35, s[36:39], 0 offen nt
    s_mov_b32 s80, 32768
    buffer_load_dwordx4 a[196:199], v35, s[36:39], s80 offen nt
    s_mov_b32 s80, 65536
    buffer_load_dwordx4 a[200:203], v35, s[36:39], s80 offen nt
    s_mov_b32 s80, 98304
    buffer_load_dwordx4 a[204:207], v35, s[36:39], s80 offen nt
    s_mul_i32 s76, s68, 43
    s_add_u32 s77, s76, 47
    s_add_u32 s76, s76, 4
    s_lshr_b32 s76, s76, 3
    s_lshr_b32 s77, s77, 3
    s_sub_u32 s77, s77, s76
    s_lshl_b32 s76, s76, 2
    s_lshl_b32 s77, s77, 2
    s_sub_u32 s84, s77, 12
    s_and_b32 s80, s69, 1
    s_cselect_b32 s84, s84, 12
    s_mul_i32 s80, s80, 12
    s_add_u32 s80, s80, s76
    s_and_b32 s79, s3, 1
    s_and_b32 s78, s69, 30
    s_add_u32 s79, s79, s78
    s_lshl_b32 s79, s79, 4
    v_add_u32 v31, s79, v28
    v_mul_u32_u24 v31, 2752, v31
    v_cmp_gt_u32 vcc, s84, v29
    v_add_u32 v32, s80, v29
    v_lshl_add_u32 v31, v32, 4, v31
    v_mov_b32 v33, 1073741824
    v_cndmask_b32 v36, v33, v31, vcc
    s_cmp_lt_u32 s3, 2
    s_cselect_b32 s44, s16, s18
    s_cselect_b32 s45, s17, s19
    s_mov_b32 s46, 1409024
    s_mov_b32 s47, 0x20000
    buffer_load_dwordx4 a[208:211], v36, s[44:47], 0 offen nt
    s_mov_b32 s80, 11008
    buffer_load_dwordx4 a[212:215], v36, s[44:47], s80 offen nt
    s_mov_b32 s80, 22016
    buffer_load_dwordx4 a[216:219], v36, s[44:47], s80 offen nt
    s_mov_b32 s80, 33024
    buffer_load_dwordx4 a[220:223], v36, s[44:47], s80 offen nt
    s_lshl2_add_u32 s78, s74, s3
    s_lshl_b32 s78, s78, 4
    v_and_b32 v33, 4, v15
    v_cmp_eq_u32 vcc, 0, v33
    v_mov_b32 v32, s78
    v_mov_b32 v33, s79
    v_and_b32 v31, 3, v15
    v_cndmask_b32 v32, v33, v32, vcc
    v_lshl_add_u32 v31, v31, 2, v28
    v_bfe_u32 v33, v15, 3, 1
    v_add_u32 v31, v31, v32
    v_lshl_add_u32 v31, v33, 9, v31
    v_lshlrev_b32 v34, 1, v31
    buffer_load_ushort v232, v34, s[52:55], 0 offen
    buffer_load_dwordx4 v[64:67], v1, s[28:31], s81 offen nt
    s_addk_i32 s81, 0x1000
    s_and_b32 s81, s81, s83
    buffer_load_dwordx4 v[68:71], v1, s[28:31], s81 offen nt
    s_addk_i32 s81, 0x1000
    s_and_b32 s81, s81, s83
    s_mov_b32 s34, 0x40000
    s_mov_b32 s35, 0x20000
    s_lshl_b32 s78, s71, 17
    s_add_u32 s40, s12, s78
    s_addc_u32 s41, s13, 0
    s_mov_b32 s42, 0x20000
    s_mov_b32 s43, 0x20000
    s_mov_b32 s48, s20
    s_mov_b32 s49, s21
    s_mov_b32 s50, 1409024
    s_mov_b32 s51, 0x20000
    s_mov_b32 s56, s26
    s_mov_b32 s57, s27
    s_mov_b32 s58, 1363968
    s_mov_b32 s59, 0x20000
    s_mov_b32 s60, s22
    s_mov_b32 s61, s23
    s_mov_b32 s62, 2048
    s_mov_b32 s63, 0x20000
    s_lshl3_add_u32 s78, s71, s74
    s_lshl2_add_u32 s78, s78, s3
    s_lshl_b32 s78, s78, 8
    s_add_u32 s78, s78, 524288
    s_lshl_b32 s79, s68, 5
    s_add_u32 s79, s79, s69
    s_mul_i32 s79, s79, 2176
    s_lshl_b32 s80, s3, 9
    s_add_u32 s79, s79, s80
    s_add_u32 s79, s79, 806656
    v_mov_b32 v30, s78
    v_mov_b32 v31, s79
    v_cmp_gt_u32 vcc, 2, v15
    v_mov_b32 v32, 1073741824
    s_nop 0
    v_cndmask_b32 v30, v31, v30, vcc
    v_cmp_gt_u32 vcc, 5, v15
    v_lshl_add_u32 v30, v15, 7, v30
    s_nop 0
    v_cndmask_b32 v30, v32, v30, vcc
    buffer_load_dword a246, v30, s[56:59], 0 offen nt
    v_and_b32 v30, 1, v15
    v_lshlrev_b32 v30, 4, v30
    v_mov_b32 v31, 0xffff
    v_lshlrev_b32 v30, v30, v31
    v_bfe_u32 v31, v15, 1, 2
    v_cmp_eq_u32 s[4:5], 0, v31
    v_cmp_eq_u32 s[6:7], 1, v31
    v_cmp_eq_u32 s[8:9], 2, v31
    v_cmp_eq_u32 s[10:11], 3, v31
    v_cndmask_b32 v2, 0, v30, s[4:5]
    v_cndmask_b32 v3, 0, v30, s[6:7]
    v_cndmask_b32 v4, 0, v30, s[8:9]
    v_cndmask_b32 v5, 0, v30, s[10:11]
    s_mov_b32 s94, 0xcccccccc
    s_mov_b32 s95, 0xcccccccc
    s_mov_b32 s96, 0xaaaaaaaa
    s_mov_b32 s97, 0xaaaaaaaa
    s_mov_b32 s88, 0x05040100
    s_mov_b32 s89, 0x07060302
    s_movk_i32 s91, 0xff
    s_movk_i32 s92, 0xfff
    s_movk_i32 s93, 7
    s_getreg_b32 s86, hwreg(HW_REG_XCC_ID, 0, 4)
    s_waitcnt vmcnt(12)
    v_lshlrev_b32 v216, 16, v208
    v_and_b32 v217, 0xffff0000, v208
    v_lshlrev_b32 v218, 16, v209
    v_and_b32 v219, 0xffff0000, v209
    v_lshlrev_b32 v220, 16, v210
    v_and_b32 v221, 0xffff0000, v210
    v_lshlrev_b32 v222, 16, v211
    v_and_b32 v223, 0xffff0000, v211
    v_lshlrev_b32 v224, 16, v212
    v_and_b32 v225, 0xffff0000, v212
    v_lshlrev_b32 v226, 16, v213
    v_and_b32 v227, 0xffff0000, v213
    v_lshlrev_b32 v228, 16, v214
    v_and_b32 v229, 0xffff0000, v214
    v_lshlrev_b32 v230, 16, v215
    v_and_b32 v231, 0xffff0000, v215
    v_pk_add_f32 v[208:209], v[216:217], v[218:219]
    v_pk_add_f32 v[210:211], v[220:221], v[222:223]
    v_pk_add_f32 v[212:213], v[224:225], v[226:227]
    v_pk_add_f32 v[214:215], v[228:229], v[230:231]
    v_pk_add_f32 v[208:209], v[208:209], v[210:211]
    v_pk_add_f32 v[212:213], v[212:213], v[214:215]
    v_pk_add_f32 v[208:209], v[208:209], v[212:213]
    v_add_f32 v30, v208, v209
    buffer_load_dwordx4 v[72:75], v1, s[28:31], s81 offen nt
    s_addk_i32 s81, 0x1000
    s_and_b32 s81, s81, s83
    buffer_load_dwordx4 v[76:79], v1, s[28:31], s81 offen nt
    s_addk_i32 s81, 0x1000
    s_and_b32 s81, s81, s83
    buffer_load_dwordx4 v[80:83], v1, s[28:31], s81 offen nt
    s_addk_i32 s81, 0x1000
    s_and_b32 s81, s81, s83
    v_add_f32_dpp v30, v30, v30 row_ror:8 row_mask:0xf bank_mask:0xf
    s_nop 1
    v_add_f32_dpp v30, v30, v30 row_ror:4 row_mask:0xf bank_mask:0xf
    s_nop 1
    v_add_f32_dpp v30, v30, v30 row_ror:2 row_mask:0xf bank_mask:0xf
    s_nop 1
    v_add_f32_dpp v30, v30, v30 row_ror:1 row_mask:0xf bank_mask:0xf
    v_mov_b32 v31, v30
    s_nop 1
    v_permlane16_swap_b32 v30, v31
    v_add_f32 v30, v30, v31
    v_mul_f32 v30, 0x3b000000, v30
    v_pk_add_f32 v[216:217], v[216:217], v[30:31] op_sel_hi:[1,0] neg_lo:[0,1] neg_hi:[0,1]
    v_pk_add_f32 v[218:219], v[218:219], v[30:31] op_sel_hi:[1,0] neg_lo:[0,1] neg_hi:[0,1]
    v_pk_add_f32 v[220:221], v[220:221], v[30:31] op_sel_hi:[1,0] neg_lo:[0,1] neg_hi:[0,1]
    v_pk_add_f32 v[222:223], v[222:223], v[30:31] op_sel_hi:[1,0] neg_lo:[0,1] neg_hi:[0,1]
    v_pk_add_f32 v[224:225], v[224:225], v[30:31] op_sel_hi:[1,0] neg_lo:[0,1] neg_hi:[0,1]
    v_pk_add_f32 v[226:227], v[226:227], v[30:31] op_sel_hi:[1,0] neg_lo:[0,1] neg_hi:[0,1]
    v_pk_add_f32 v[228:229], v[228:229], v[30:31] op_sel_hi:[1,0] neg_lo:[0,1] neg_hi:[0,1]
    v_pk_add_f32 v[230:231], v[230:231], v[30:31] op_sel_hi:[1,0] neg_lo:[0,1] neg_hi:[0,1]
    buffer_load_dwordx4 v[84:87], v1, s[28:31], s81 offen nt
    s_addk_i32 s81, 0x1000
    s_and_b32 s81, s81, s83
    buffer_load_dwordx4 v[88:91], v1, s[28:31], s81 offen nt
    s_addk_i32 s81, 0x1000
    s_and_b32 s81, s81, s83
    v_pk_mul_f32 v[208:209], v[216:217], v[216:217]
    v_pk_mul_f32 v[210:211], v[218:219], v[218:219]
    v_pk_fma_f32 v[208:209], v[220:221], v[220:221], v[208:209]
    v_pk_fma_f32 v[210:211], v[222:223], v[222:223], v[210:211]
    v_pk_fma_f32 v[208:209], v[224:225], v[224:225], v[208:209]
    v_pk_fma_f32 v[210:211], v[226:227], v[226:227], v[210:211]
    v_pk_fma_f32 v[208:209], v[228:229], v[228:229], v[208:209]
    v_pk_fma_f32 v[210:211], v[230:231], v[230:231], v[210:211]
    v_pk_add_f32 v[208:209], v[208:209], v[210:211]
    v_add_f32 v32, v208, v209
    buffer_load_dwordx4 v[92:95], v1, s[28:31], s81 offen nt
    s_addk_i32 s81, 0x1000
    s_and_b32 s81, s81, s83
    buffer_load_dwordx4 v[96:99], v1, s[28:31], s81 offen nt
    s_addk_i32 s81, 0x1000
    s_and_b32 s81, s81, s83
    buffer_load_dwordx4 v[100:103], v1, s[28:31], s81 offen nt
    s_addk_i32 s81, 0x1000
    s_and_b32 s81, s81, s83
    v_add_f32_dpp v32, v32, v32 row_ror:8 row_mask:0xf bank_mask:0xf
    s_nop 1
    v_add_f32_dpp v32, v32, v32 row_ror:4 row_mask:0xf bank_mask:0xf
    s_nop 1
    v_add_f32_dpp v32, v32, v32 row_ror:2 row_mask:0xf bank_mask:0xf
    s_nop 1
    v_add_f32_dpp v32, v32, v32 row_ror:1 row_mask:0xf bank_mask:0xf
    v_mov_b32 v31, v32
    s_nop 1
    v_permlane16_swap_b32 v32, v31
    v_add_f32 v32, v32, v31
    v_mul_f32 v32, 0x3b000000, v32
    v_cvt_pk_bf16_f32 v30, v30, v30
    v_and_b32 v30, 0xffff0000, v30
    v_cvt_pk_bf16_f32 v32, v32, v32
    v_and_b32 v32, 0xffff0000, v32
    v_add_f32 v32, 0x3727c5ac, v32
    v_cvt_pk_bf16_f32 v32, v32, v32
    v_and_b32 v32, 0xffff0000, v32
    v_sqrt_f32 v32, v32
    s_nop 0
    v_cvt_pk_bf16_f32 v32, v32, v32
    v_and_b32 v32, 0xffff0000, v32
    v_mov_b32 v31, v30
    v_mov_b32 v33, v32
    v_and_b32 v208, 8, v15
    v_permlane32_swap_b32 v30, v31
    v_permlane32_swap_b32 v32, v33
    v_cmp_eq_u32 vcc, 0, v208
    s_nop 1
    v_cndmask_b32 v30, v31, v30, vcc
    v_cndmask_b32 v32, v33, v32, vcc
    s_waitcnt vmcnt(11)
    v_lshlrev_b32 v232, 16, v232
    v_sub_f32 v232, v232, v30
    v_rcp_f32 v33, v32
    v_cvt_pk_bf16_f32 v232, v232, v232
    v_and_b32 v232, 0xffff0000, v232
    v_mul_f32 v30, v232, v33
    v_fma_f32 v31, -v30, v32, v232
    v_fmac_f32 v30, v31, v33
    v_cvt_pk_bf16_f32 v232, v30, v30
    buffer_load_dwordx4 v[104:107], v1, s[28:31], s81 offen nt
    s_addk_i32 s81, 0x1000
    s_and_b32 s81, s81, s83
    buffer_load_dwordx4 v[108:111], v1, s[28:31], s81 offen nt
    s_addk_i32 s81, 0x1000
    s_and_b32 s81, s81, s83
    v_and_b32_dpp v16, v232, v2 row_newbcast:0 row_mask:0xf bank_mask:0x3
    v_and_b32_dpp v17, v232, v3 row_newbcast:0 row_mask:0xf bank_mask:0x3
    v_and_b32_dpp v18, v232, v4 row_newbcast:0 row_mask:0xf bank_mask:0x3
    v_and_b32_dpp v19, v232, v5 row_newbcast:0 row_mask:0xf bank_mask:0x3
    v_and_b32_dpp v16, v232, v2 row_newbcast:8 row_mask:0xf bank_mask:0xc
    v_and_b32_dpp v17, v232, v3 row_newbcast:8 row_mask:0xf bank_mask:0xc
    v_and_b32_dpp v18, v232, v4 row_newbcast:8 row_mask:0xf bank_mask:0xc
    v_and_b32_dpp v19, v232, v5 row_newbcast:8 row_mask:0xf bank_mask:0xc
    s_nop 1
    v_mfma_f32_16x16x32_bf16 v[236:239], v[16:19], a[192:195], 0
    v_and_b32_dpp v20, v232, v2 row_newbcast:1 row_mask:0xf bank_mask:0x3
    v_and_b32_dpp v21, v232, v3 row_newbcast:1 row_mask:0xf bank_mask:0x3
    v_and_b32_dpp v22, v232, v4 row_newbcast:1 row_mask:0xf bank_mask:0x3
    v_and_b32_dpp v23, v232, v5 row_newbcast:1 row_mask:0xf bank_mask:0x3
    v_and_b32_dpp v20, v232, v2 row_newbcast:9 row_mask:0xf bank_mask:0xc
    v_and_b32_dpp v21, v232, v3 row_newbcast:9 row_mask:0xf bank_mask:0xc
    v_and_b32_dpp v22, v232, v4 row_newbcast:9 row_mask:0xf bank_mask:0xc
    v_and_b32_dpp v23, v232, v5 row_newbcast:9 row_mask:0xf bank_mask:0xc
    s_nop 1
    v_mfma_f32_16x16x32_bf16 v[236:239], v[20:23], a[196:199], v[236:239]
    v_and_b32_dpp v16, v232, v2 row_newbcast:2 row_mask:0xf bank_mask:0x3
    v_and_b32_dpp v17, v232, v3 row_newbcast:2 row_mask:0xf bank_mask:0x3
    v_and_b32_dpp v18, v232, v4 row_newbcast:2 row_mask:0xf bank_mask:0x3
    v_and_b32_dpp v19, v232, v5 row_newbcast:2 row_mask:0xf bank_mask:0x3
    v_and_b32_dpp v16, v232, v2 row_newbcast:10 row_mask:0xf bank_mask:0xc
    v_and_b32_dpp v17, v232, v3 row_newbcast:10 row_mask:0xf bank_mask:0xc
    v_and_b32_dpp v18, v232, v4 row_newbcast:10 row_mask:0xf bank_mask:0xc
    v_and_b32_dpp v19, v232, v5 row_newbcast:10 row_mask:0xf bank_mask:0xc
    s_nop 1
    v_mfma_f32_16x16x32_bf16 v[236:239], v[16:19], a[200:203], v[236:239]
    v_and_b32_dpp v20, v232, v2 row_newbcast:3 row_mask:0xf bank_mask:0x3
    v_and_b32_dpp v21, v232, v3 row_newbcast:3 row_mask:0xf bank_mask:0x3
    v_and_b32_dpp v22, v232, v4 row_newbcast:3 row_mask:0xf bank_mask:0x3
    v_and_b32_dpp v23, v232, v5 row_newbcast:3 row_mask:0xf bank_mask:0x3
    v_and_b32_dpp v20, v232, v2 row_newbcast:11 row_mask:0xf bank_mask:0xc
    v_and_b32_dpp v21, v232, v3 row_newbcast:11 row_mask:0xf bank_mask:0xc
    v_and_b32_dpp v22, v232, v4 row_newbcast:11 row_mask:0xf bank_mask:0xc
    v_and_b32_dpp v23, v232, v5 row_newbcast:11 row_mask:0xf bank_mask:0xc
    s_nop 1
    v_mfma_f32_16x16x32_bf16 v[236:239], v[20:23], a[204:207], v[236:239]
    buffer_load_dwordx4 v[112:115], v1, s[28:31], s81 offen nt
    s_addk_i32 s81, 0x1000
    s_and_b32 s81, s81, s83
    buffer_load_dwordx4 v[116:119], v1, s[28:31], s81 offen nt
    s_addk_i32 s81, 0x1000
    s_and_b32 s81, s81, s83
    v_and_b32_dpp v16, v232, v2 row_newbcast:4 row_mask:0xf bank_mask:0x3
    v_and_b32_dpp v17, v232, v3 row_newbcast:4 row_mask:0xf bank_mask:0x3
    v_and_b32_dpp v18, v232, v4 row_newbcast:4 row_mask:0xf bank_mask:0x3
    v_and_b32_dpp v19, v232, v5 row_newbcast:4 row_mask:0xf bank_mask:0x3
    v_and_b32_dpp v16, v232, v2 row_newbcast:12 row_mask:0xf bank_mask:0xc
    v_and_b32_dpp v17, v232, v3 row_newbcast:12 row_mask:0xf bank_mask:0xc
    v_and_b32_dpp v18, v232, v4 row_newbcast:12 row_mask:0xf bank_mask:0xc
    v_and_b32_dpp v19, v232, v5 row_newbcast:12 row_mask:0xf bank_mask:0xc
    s_nop 1
    v_mfma_f32_16x16x32_bf16 v[240:243], v[16:19], a[208:211], 0
    v_and_b32_dpp v20, v232, v2 row_newbcast:5 row_mask:0xf bank_mask:0x3
    v_and_b32_dpp v21, v232, v3 row_newbcast:5 row_mask:0xf bank_mask:0x3
    v_and_b32_dpp v22, v232, v4 row_newbcast:5 row_mask:0xf bank_mask:0x3
    v_and_b32_dpp v23, v232, v5 row_newbcast:5 row_mask:0xf bank_mask:0x3
    v_and_b32_dpp v20, v232, v2 row_newbcast:13 row_mask:0xf bank_mask:0xc
    v_and_b32_dpp v21, v232, v3 row_newbcast:13 row_mask:0xf bank_mask:0xc
    v_and_b32_dpp v22, v232, v4 row_newbcast:13 row_mask:0xf bank_mask:0xc
    v_and_b32_dpp v23, v232, v5 row_newbcast:13 row_mask:0xf bank_mask:0xc
    s_nop 1
    v_mfma_f32_16x16x32_bf16 v[240:243], v[20:23], a[212:215], v[240:243]
    v_and_b32_dpp v16, v232, v2 row_newbcast:6 row_mask:0xf bank_mask:0x3
    v_and_b32_dpp v17, v232, v3 row_newbcast:6 row_mask:0xf bank_mask:0x3
    v_and_b32_dpp v18, v232, v4 row_newbcast:6 row_mask:0xf bank_mask:0x3
    v_and_b32_dpp v19, v232, v5 row_newbcast:6 row_mask:0xf bank_mask:0x3
    v_and_b32_dpp v16, v232, v2 row_newbcast:14 row_mask:0xf bank_mask:0xc
    v_and_b32_dpp v17, v232, v3 row_newbcast:14 row_mask:0xf bank_mask:0xc
    v_and_b32_dpp v18, v232, v4 row_newbcast:14 row_mask:0xf bank_mask:0xc
    v_and_b32_dpp v19, v232, v5 row_newbcast:14 row_mask:0xf bank_mask:0xc
    s_nop 1
    v_mfma_f32_16x16x32_bf16 v[240:243], v[16:19], a[216:219], v[240:243]
    v_and_b32_dpp v20, v232, v2 row_newbcast:7 row_mask:0xf bank_mask:0x3
    v_and_b32_dpp v21, v232, v3 row_newbcast:7 row_mask:0xf bank_mask:0x3
    v_and_b32_dpp v22, v232, v4 row_newbcast:7 row_mask:0xf bank_mask:0x3
    v_and_b32_dpp v23, v232, v5 row_newbcast:7 row_mask:0xf bank_mask:0x3
    v_and_b32_dpp v20, v232, v2 row_newbcast:15 row_mask:0xf bank_mask:0xc
    v_and_b32_dpp v21, v232, v3 row_newbcast:15 row_mask:0xf bank_mask:0xc
    v_and_b32_dpp v22, v232, v4 row_newbcast:15 row_mask:0xf bank_mask:0xc
    v_and_b32_dpp v23, v232, v5 row_newbcast:15 row_mask:0xf bank_mask:0xc
    s_nop 1
    v_mfma_f32_16x16x32_bf16 v[240:243], v[20:23], a[220:223], v[240:243]
    ds_write_b128 v1, v[236:239]
    s_lshr_b32 s78, s3, 1
    s_lshl_b32 s78, s78, 9
    s_and_b32 s79, s3, 1
    s_lshl3_add_u32 s78, s79, s78
    v_and_b32 v31, 31, v15
    v_lshl_add_u32 v208, v31, 4, s78
    s_lshl_b32 s78, s3, 8
    v_lshl_add_u32 v209, v29, 4, s78
    ds_write_b128 v1, v[240:243] offset:4096
    s_lshl_b32 s79, s68, 5
    s_add_u32 s79, s79, s69
    s_mul_i32 s79, s79, 2176
    s_lshl1_add_u32 s79, s78, s79
    s_add_u32 s79, s79, 806912
    v_and_b32 v31, 47, v15
    v_cmp_gt_u32 vcc, s84, v31
    v_lshl_add_u32 v31, v29, 1, v28
    v_lshl_add_u32 v31, v31, 4, s79
    v_mov_b32 v33, 1073741824
    v_cndmask_b32 v210, v33, v31, vcc
    s_lshl3_add_u32 s79, s71, s74
    s_lshl_b32 s79, s79, 10
    s_add_u32 s79, s79, 524288
    v_add_u32 v31, s79, v209
    v_cmp_gt_u32 vcc, 16, v15
    s_nop 1
    v_cndmask_b32 v211, v33, v31, vcc
    s_waitcnt lgkmcnt(0)
    s_barrier
    ds_read_b128 v[216:219], v209 offset:0
    ds_read_b128 v[220:223], v209 offset:1024
    ds_read_b128 v[224:227], v209 offset:2048
    ds_read_b128 v[228:231], v209 offset:3072
    ds_read_b64 v[232:233], v208 offset:4096
    ds_read_b64 v[234:235], v208 offset:5120
    ds_read_b64 v[236:237], v208 offset:6144
    ds_read_b64 v[238:239], v208 offset:7168
    s_add_u32 s0, s0, 1
    s_and_b32 s79, s0, s92
    v_mov_b32 v0, s79
    v_xor_b32 v38, s86, v0
    s_xor_b32 s86, s86, s0
    v_accvgpr_write_b32 a232, v211
    v_accvgpr_write_b32 a233, v210
    s_waitcnt lgkmcnt(4)
    v_pk_add_f32 v[216:217], v[216:217], v[220:221]
    v_pk_add_f32 v[218:219], v[218:219], v[222:223]
    v_pk_add_f32 v[224:225], v[224:225], v[228:229]
    v_pk_add_f32 v[226:227], v[226:227], v[230:231]
    v_pk_add_f32 v[216:217], v[216:217], v[224:225]
    v_pk_add_f32 v[218:219], v[218:219], v[226:227]
    v_bfi_b32 v216, s93, v0, v216
    v_bfi_b32 v217, s93, v0, v217
    v_bfi_b32 v218, s93, v38, v218
    v_bfi_b32 v219, s93, v38, v219
    buffer_store_dwordx4 v[216:219], v211, s[56:59], 0 offen
    s_waitcnt lgkmcnt(0)
    v_add_f32 v240, v232, v234
    v_add_f32 v241, v236, v238
    v_add_f32 v242, v233, v235
    v_add_f32 v243, v237, v239
    v_bfi_b32 v240, s91, v0, v240
    v_bfi_b32 v241, s91, v0, v241
    v_bfi_b32 v242, s91, v0, v242
    v_bfi_b32 v243, s91, v38, v243
    buffer_store_dwordx4 v[240:243], v210, s[56:59], 0 offen
    v_accvgpr_write_b32 a224, v216
    v_accvgpr_write_b32 a228, v240
    v_accvgpr_write_b32 a225, v217
    v_accvgpr_write_b32 a229, v241
    v_accvgpr_write_b32 a226, v218
    v_accvgpr_write_b32 a230, v242
    v_accvgpr_write_b32 a227, v219
    v_accvgpr_write_b32 a231, v243
    buffer_load_dwordx4 v[120:123], v1, s[28:31], s81 offen nt
    s_addk_i32 s81, 0x1000
    s_and_b32 s81, s81, s83
    buffer_load_dwordx4 v[124:127], v1, s[28:31], s81 offen nt
    s_addk_i32 s81, 0x1000
    s_and_b32 s81, s81, s83
    s_lshl2_add_u32 s84, s71, s73
    s_lshl2_add_u32 s78, s72, s3
    s_lshl_b32 s78, s78, 9
    s_add_u32 s78, s78, s84
    s_lshl_b32 s78, s78, 7
    v_lshrrev_b32 v30, 2, v29
    v_lshlrev_b32 v30, 14, v30
    v_and_b32 v31, 3, v15
    v_lshl_add_u32 v30, v31, 5, v30
    v_lshl_add_u32 v30, v28, 4, v30
    v_add_u32 v14, s78, v30
    v_lshrrev_b32 v32, 4, v14
    v_xor_b32 v32, v32, v14
    v_and_b32 v32, 0x2000, v32
    v_lshl_or_b32 v32, v32, 4, v32
    v_xor_b32 v14, v32, v14
    s_lshl2_add_u32 s79, s75, s73
    s_lshl2_add_u32 s79, s79, s3
    s_lshl4_add_u32 s79, s79, 786432
    v_mov_b32 v32, s79
    v_cmp_eq_u32 vcc, 0, v15
    v_mul_u32_u24 v31, 320, v31
    s_nop 0
    v_cndmask_b32 v37, v33, v32, vcc
    v_lshl_add_u32 v46, v28, 4, v31
    s_mul_i32 s78, s3, 320
    s_add_u32 s78, s78, 8192
    v_and_b32 v30, 1, v28
    v_lshlrev_b32 v31, 3, v30
    v_lshl_add_u32 v31, v29, 4, v31
    v_add_u32 v45, s78, v31
    v_lshrrev_b32 v31, 1, v31
    v_add_u32 v45, s78, v31
    v_bfe_u32 v31, v15, 2, 1
    v_lshl_add_u32 v46, v31, 7, v46
    s_lshl2_add_u32 s85, s70, s73
    s_lshr_b32 s79, s85, 3
    s_lshl1_add_u32 s79, s68, s79
    s_lshl4_add_u32 s79, s72, s79
    s_and_b32 s78, s85, 7
    s_and_b32 s1, s85, 3
    s_lshl_b32 s80, s79, 14
    s_lshl4_add_u32 s80, s78, s80
    s_lshl_b32 s74, s3, 12
    s_add_u32 s80, s80, s74
    v_lshrrev_b32 v31, 2, v15
    v_lshl_add_u32 v31, v31, 7, s80
    v_and_b32 v32, 3, v15
    v_lshl_add_u32 v44, v32, 4, v31
    v_lshrrev_b32 v32, 4, v44
    v_xor_b32 v32, v32, v44
    v_and_b32 v32, 0x2000, v32
    v_lshl_or_b32 v32, v32, 4, v32
    v_xor_b32 v44, v32, v44
    s_lshl3_add_u32 s79, s79, s78
    s_lshl_b32 s79, s79, 3
    v_lshrrev_b32 v31, 1, v28
    v_lshl_add_u32 v30, v30, 1, v31
    v_lshl_add_u32 v30, v29, 2, v30
    v_lshl_add_u32 v30, v30, 1, s79
    v_cmp_gt_u32 vcc, 4, v29
    s_nop 1
    v_cndmask_b32 v43, v33, v30, vcc
    buffer_load_dwordx4 v[128:131], v1, s[28:31], s81 offen nt
    s_addk_i32 s81, 0x1000
    s_and_b32 s81, s81, s83
    s_lshl_b32 s78, s71, 13
    s_lshl_b32 s79, s72, 9
    s_add_u32 s78, s78, s79
    s_add_u32 s78, s78, 524288
    v_lshlrev_b32 v30, 10, v28
    v_lshl_add_u32 v30, v29, 4, v30
    v_add_u32 v39, s78, v30
    s_lshl_b32 s78, s3, 8
    v_lshl_add_u32 v30, v29, 4, s78
    v_lshl_add_u32 v40, v28, 13, v30
    s_mul_i32 s85, s85, 12
    s_lshl_b32 s77, s77, 3
    s_lshl3_add_u32 s78, s76, s85
    s_lshl_b32 s78, s78, 10
    s_cmp_lt_u32 s85, s77
    s_cselect_b32 s78, s78, 1073741824
    s_cselect_b32 s85, s85, 0
    v_lshl_add_u32 v30, v28, 12, v30
    v_add_u32 v30, s78, v30
    v_cmp_gt_u32 vcc, 3, v28
    s_nop 1
    v_cndmask_b32 v41, v33, v30, vcc
    buffer_load_dwordx4 v[132:135], v1, s[28:31], s81 offen nt
    s_addk_i32 s81, 0x1000
    s_and_b32 s81, s81, s83
    v_and_b32 v30, 7, v15
    v_cmp_gt_u32 s[24:25], 6, v30
    v_lshl_add_u32 v30, v30, 1, s85
    s_movk_i32 s79, 96
    s_cmp_ge_u32 s85, s79
    s_cselect_b32 s78, 0, s79
    v_mov_b32 v31, s78
    v_cndmask_b32 v30, v31, v30, s[24:25]
    v_cmp_le_u32 s[24:25], s79, v30
    v_cmp_gt_u32 vcc, s77, v30
    v_lshrrev_b32 v32, 3, v15
    v_cndmask_b32 v31, 0, 1, s[24:25]
    v_lshl_add_u32 v32, v32, 1, v31
    v_mul_u32_u24 v32, 2176, v32
    v_mul_u32_u24 v31, 96, v31
    v_sub_u32 v30, v30, v31
    v_bfe_u32 v31, v30, 1, 1
    v_lshl_add_u32 v32, v31, 9, v32
    v_lshrrev_b32 v30, 2, v30
    v_lshl_add_u32 v30, v30, 4, v32
    s_mul_i32 s78, s68, 69632
    s_lshl_b32 s79, s72, 10
    s_add_u32 s78, s78, s79
    s_add_u32 s78, s78, 806912
    v_add_u32 v30, s78, v30
    v_cndmask_b32 v42, v33, v30, vcc
    s_waitcnt vmcnt(9)
    buffer_load_dwordx4 v[136:139], v1, s[28:31], s81 offen nt
    s_addk_i32 s81, 0x1000
    s_and_b32 s81, s81, s83
    s_waitcnt vmcnt(9)
    s_mov_b32 s78, 0
    buffer_load_dwordx4 a[64:67], v40, s[40:43], s78 offen offset:0 nt
    s_waitcnt vmcnt(9)
    buffer_load_dwordx4 v[140:143], v1, s[28:31], s81 offen nt
    s_addk_i32 s81, 0x1000
    s_and_b32 s81, s81, s83
    s_waitcnt vmcnt(9)
    buffer_load_dwordx4 v[144:147], v1, s[28:31], s81 offen nt
    s_addk_i32 s81, 0x1000
    s_and_b32 s81, s81, s83
    s_waitcnt vmcnt(9)
    s_mov_b32 s78, 0
    buffer_load_dwordx4 a[68:71], v40, s[40:43], s78 offen offset:1024 nt
    s_waitcnt vmcnt(9)
    buffer_load_dwordx4 v[148:151], v1, s[28:31], s81 offen nt
    s_addk_i32 s81, 0x1000
    s_and_b32 s81, s81, s83
    s_waitcnt vmcnt(9)
    buffer_load_dwordx4 v[152:155], v1, s[28:31], s81 offen nt
    s_addk_i32 s81, 0x1000
    s_and_b32 s81, s81, s83
    s_waitcnt vmcnt(9)
    buffer_load_dwordx4 v[156:159], v1, s[28:31], s81 offen nt
    s_addk_i32 s81, 0x1000
    s_and_b32 s81, s81, s83
    s_waitcnt vmcnt(9)
    s_mov_b32 s78, 0
    buffer_load_dwordx4 a[72:75], v40, s[40:43], s78 offen offset:2048 nt
    s_waitcnt vmcnt(9)
    buffer_load_dwordx4 v[160:163], v1, s[28:31], s81 offen nt
    s_addk_i32 s81, 0x1000
    s_and_b32 s81, s81, s83
    s_waitcnt vmcnt(9)
    buffer_load_dwordx4 v[164:167], v1, s[28:31], s81 offen nt
    s_addk_i32 s81, 0x1000
    s_and_b32 s81, s81, s83
    s_waitcnt vmcnt(9)
    buffer_load_dwordx4 v[168:171], v1, s[28:31], s81 offen nt
    s_addk_i32 s81, 0x1000
    s_and_b32 s81, s81, s83
    s_waitcnt vmcnt(9)
    s_mov_b32 s78, 0
    buffer_load_dwordx4 a[76:79], v40, s[40:43], s78 offen offset:3072 nt
    s_waitcnt vmcnt(9)
    buffer_load_dwordx4 v[172:175], v1, s[28:31], s81 offen nt
    s_addk_i32 s81, 0x1000
    s_and_b32 s81, s81, s83
    s_waitcnt vmcnt(9)
    buffer_load_dwordx4 v[176:179], v1, s[28:31], s81 offen nt
    s_addk_i32 s81, 0x1000
    s_and_b32 s81, s81, s83
    s_waitcnt vmcnt(9)
    buffer_load_dwordx4 v[180:183], v1, s[28:31], s81 offen nt
    s_addk_i32 s81, 0x1000
    s_and_b32 s81, s81, s83
    s_waitcnt vmcnt(9)
    s_mov_b32 s78, 4096
    buffer_load_dwordx4 a[80:83], v40, s[40:43], s78 offen offset:0 nt
    s_waitcnt vmcnt(9)
    buffer_load_dwordx4 v[184:187], v1, s[28:31], s81 offen nt
    s_addk_i32 s81, 0x1000
    s_and_b32 s81, s81, s83
    s_waitcnt vmcnt(9)
    buffer_load_dwordx4 v[232:235], v39, s[56:59], 0 offen offset:0
    buffer_load_dwordx4 v[236:239], v39, s[56:59], 0 offen offset:256
    s_movk_i32 s78, 0x1000
    buffer_load_dwordx4 v[240:243], v39, s[56:59], s78 offen offset:0
    buffer_load_dwordx4 v[244:247], v39, s[56:59], s78 offen offset:256
    s_waitcnt vmcnt(9)
    buffer_load_dwordx4 v[188:191], v1, s[28:31], s81 offen nt
    s_addk_i32 s81, 0x1000
    s_and_b32 s81, s81, s83
    s_waitcnt vmcnt(9)
    s_mov_b32 s78, 4096
    buffer_load_dwordx4 a[84:87], v40, s[40:43], s78 offen offset:1024 nt
    s_waitcnt vmcnt(9)
    buffer_load_dwordx4 v[192:195], v1, s[28:31], s81 offen nt
    s_addk_i32 s81, 0x1000
    s_and_b32 s81, s81, s83
    s_waitcnt vmcnt(9)
    buffer_load_dwordx4 v[196:199], v1, s[28:31], s81 offen nt
    s_addk_i32 s81, 0x1000
    s_and_b32 s81, s81, s83
    s_waitcnt vmcnt(9)
    buffer_load_dwordx4 v[200:203], v1, s[28:31], s81 offen nt
    s_addk_i32 s81, 0x1000
    s_and_b32 s81, s81, s83
    s_waitcnt vmcnt(9)
    s_mov_b32 s78, 4096
    buffer_load_dwordx4 a[88:91], v40, s[40:43], s78 offen offset:2048 nt
    s_waitcnt vmcnt(9)
    buffer_load_dwordx4 v[204:207], v1, s[28:31], s81 offen nt
    s_addk_i32 s81, 0x1000
    s_and_b32 s81, s81, s83
    s_waitcnt vmcnt(9)
    buffer_load_dwordx4 v[208:211], v1, s[28:31], s81 offen nt
    s_addk_i32 s81, 0x1000
    s_and_b32 s81, s81, s83
    s_waitcnt vmcnt(9)
    buffer_load_dwordx4 v[212:215], v1, s[28:31], s81 offen nt
    s_addk_i32 s81, 0x1000
    s_and_b32 s81, s81, s83
    s_waitcnt vmcnt(9)
    s_mov_b32 s78, 4096
    buffer_load_dwordx4 a[92:95], v40, s[40:43], s78 offen offset:3072 nt
    s_waitcnt vmcnt(9)
    buffer_load_dwordx4 v[216:219], v1, s[28:31], s81 offen nt
    s_addk_i32 s81, 0x1000
    s_and_b32 s81, s81, s83
    s_waitcnt vmcnt(9)
    buffer_load_dwordx4 v[220:223], v1, s[28:31], s81 offen nt
    s_addk_i32 s81, 0x1000
    s_and_b32 s81, s81, s83
    s_waitcnt vmcnt(9)
    buffer_load_dwordx4 v[224:227], v1, s[28:31], s81 offen nt
    s_addk_i32 s81, 0x1000
    s_and_b32 s81, s81, s83
    s_waitcnt vmcnt(9)
    s_mov_b32 s78, 32768
    buffer_load_dwordx4 a[96:99], v40, s[40:43], s78 offen offset:0 nt
    s_waitcnt vmcnt(9)
    buffer_load_dwordx4 v[228:231], v1, s[28:31], s81 offen nt
    s_addk_i32 s81, 0x1000
    s_and_b32 s81, s81, s83
    v_and_b32 v32, 7, v0
    v_and_b32 v33, 7, v38
    v_xor_b32 v232, v32, v232
    v_xor_b32 v233, v32, v233
    v_xor_b32 v234, v33, v234
    v_xor_b32 v235, v33, v235
    v_xor_b32 v236, v32, v236
    v_xor_b32 v237, v32, v237
    v_xor_b32 v238, v33, v238
    v_xor_b32 v239, v33, v239
    v_xor_b32 v240, v32, v240
    v_xor_b32 v241, v32, v241
    v_xor_b32 v242, v33, v242
    v_xor_b32 v243, v33, v243
    v_xor_b32 v244, v32, v244
    v_xor_b32 v245, v32, v245
    v_xor_b32 v246, v33, v246
    v_xor_b32 v247, v33, v247
    v_or3_b32 v30, v232, v233, v234
    v_or3_b32 v30, v30, v235, v236
    v_or3_b32 v30, v30, v237, v238
    v_or3_b32 v30, v30, v239, v240
    v_or3_b32 v30, v30, v241, v242
    v_or3_b32 v30, v30, v243, v244
    v_or3_b32 v30, v30, v245, v246
    v_or_b32 v30, v30, v247
    v_and_b32 v30, s93, v30
    v_cmp_ne_u32 vcc, 0, v30
    s_cbranch_vccnz L_slow_q
L_ok_q:
    v_pk_add_f32 v[232:233], v[232:233], v[240:241]
    v_pk_add_f32 v[234:235], v[234:235], v[242:243]
    v_pk_add_f32 v[236:237], v[236:237], v[244:245]
    v_pk_add_f32 v[238:239], v[238:239], v[246:247]
    s_nop 0
    v_permlane32_swap_b32 v232, v236
    v_permlane32_swap_b32 v233, v237
    v_permlane32_swap_b32 v234, v238
    v_permlane32_swap_b32 v235, v239
    v_pk_add_f32 v[232:233], v[232:233], v[236:237]
    v_pk_add_f32 v[234:235], v[234:235], v[238:239]
    s_nop 1
    v_permlane16_swap_b32 v232, v234
    v_permlane16_swap_b32 v233, v235
    v_pk_add_f32 v[232:233], v[232:233], v[234:235]
    v_cvt_pk_bf16_f32 v6, v232, v233
    v_cvt_pk_bf16_f32 v7, v232, v233
    s_nop 1
    v_permlane16_swap_b32 v6, v7
    v_mov_b32 v8, v6
    v_mov_b32 v9, v7
    s_nop 0
    v_permlane32_swap_b32 v6, v8
    v_permlane32_swap_b32 v7, v9
    s_waitcnt vmcnt(9)
    v_dot2_f32_bf16 v26, v48, v6, 0
    v_dot2_f32_bf16 v27, v52, v6, 0
    v_dot2_f32_bf16 v26, v49, v7, v26
    v_dot2_f32_bf16 v27, v53, v7, v27
    v_dot2_f32_bf16 v26, v50, v8, v26
    v_dot2_f32_bf16 v27, v54, v8, v27
    v_dot2_f32_bf16 v26, v51, v9, v26
    v_dot2_f32_bf16 v27, v55, v9, v27
    s_nop 1
    v_add_f32_dpp v24, v26, v26 row_ror:8 row_mask:0xf bank_mask:0x3
    s_nop 1
    v_add_f32_dpp v24, v27, v27 row_ror:8 row_mask:0xf bank_mask:0xc
    v_dot2_f32_bf16 v26, v56, v6, 0
    v_dot2_f32_bf16 v27, v60, v6, 0
    v_dot2_f32_bf16 v26, v57, v7, v26
    v_dot2_f32_bf16 v27, v61, v7, v27
    v_dot2_f32_bf16 v26, v58, v8, v26
    v_dot2_f32_bf16 v27, v62, v8, v27
    v_dot2_f32_bf16 v26, v59, v9, v26
    v_dot2_f32_bf16 v27, v63, v9, v27
    s_nop 1
    v_add_f32_dpp v25, v26, v26 row_ror:8 row_mask:0xf bank_mask:0x3
    s_nop 1
    v_add_f32_dpp v25, v27, v27 row_ror:8 row_mask:0xf bank_mask:0xc
    v_add_f32_dpp v20, v24, v24 row_shl:4 row_mask:0xf bank_mask:0x5
    s_nop 1
    v_add_f32_dpp v20, v25, v25 row_shr:4 row_mask:0xf bank_mask:0xa
    v_dot2_f32_bf16 v26, v64, v6, 0
    v_dot2_f32_bf16 v27, v68, v6, 0
    v_dot2_f32_bf16 v26, v65, v7, v26
    v_dot2_f32_bf16 v27, v69, v7, v27
    v_dot2_f32_bf16 v26, v66, v8, v26
    v_dot2_f32_bf16 v27, v70, v8, v27
    v_dot2_f32_bf16 v26, v67, v9, v26
    v_dot2_f32_bf16 v27, v71, v9, v27
    s_nop 1
    v_add_f32_dpp v24, v26, v26 row_ror:8 row_mask:0xf bank_mask:0x3
    s_nop 1
    v_add_f32_dpp v24, v27, v27 row_ror:8 row_mask:0xf bank_mask:0xc
    buffer_load_dwordx4 v[232:235], v1, s[28:31], s81 offen nt
    s_addk_i32 s81, 0x1000
    s_and_b32 s81, s81, s83
    s_waitcnt vmcnt(9)
    v_dot2_f32_bf16 v26, v72, v6, 0
    v_dot2_f32_bf16 v27, v76, v6, 0
    v_dot2_f32_bf16 v26, v73, v7, v26
    v_dot2_f32_bf16 v27, v77, v7, v27
    v_dot2_f32_bf16 v26, v74, v8, v26
    v_dot2_f32_bf16 v27, v78, v8, v27
    v_dot2_f32_bf16 v26, v75, v9, v26
    v_dot2_f32_bf16 v27, v79, v9, v27
    s_nop 1
    v_add_f32_dpp v25, v26, v26 row_ror:8 row_mask:0xf bank_mask:0x3
    s_nop 1
    v_add_f32_dpp v25, v27, v27 row_ror:8 row_mask:0xf bank_mask:0xc
    v_add_f32_dpp v21, v24, v24 row_shl:4 row_mask:0xf bank_mask:0x5
    s_nop 1
    v_add_f32_dpp v21, v25, v25 row_shr:4 row_mask:0xf bank_mask:0xa
    v_add_f32_dpp v20, v20, v20 quad_perm:[2,3,0,1] row_mask:0xf bank_mask:0xf
    s_nop 0
    v_add_f32_dpp v21, v21, v21 quad_perm:[2,3,0,1] row_mask:0xf bank_mask:0xf
    v_cndmask_b32 v22, v20, v21, s[94:95]
    v_dot2_f32_bf16 v26, v80, v6, 0
    v_dot2_f32_bf16 v27, v84, v6, 0
    v_dot2_f32_bf16 v26, v81, v7, v26
    v_dot2_f32_bf16 v27, v85, v7, v27
    v_dot2_f32_bf16 v26, v82, v8, v26
    v_dot2_f32_bf16 v27, v86, v8, v27
    v_dot2_f32_bf16 v26, v83, v9, v26
    v_dot2_f32_bf16 v27, v87, v9, v27
    s_nop 1
    v_add_f32_dpp v24, v26, v26 row_ror:8 row_mask:0xf bank_mask:0x3
    s_nop 1
    v_add_f32_dpp v24, v27, v27 row_ror:8 row_mask:0xf bank_mask:0xc
    v_dot2_f32_bf16 v26, v88, v6, 0
    v_dot2_f32_bf16 v27, v92, v6, 0
    v_dot2_f32_bf16 v26, v89, v7, v26
    v_dot2_f32_bf16 v27, v93, v7, v27
    v_dot2_f32_bf16 v26, v90, v8, v26
    v_dot2_f32_bf16 v27, v94, v8, v27
    v_dot2_f32_bf16 v26, v91, v9, v26
    v_dot2_f32_bf16 v27, v95, v9, v27
    s_nop 1
    v_add_f32_dpp v25, v26, v26 row_ror:8 row_mask:0xf bank_mask:0x3
    s_nop 1
    v_add_f32_dpp v25, v27, v27 row_ror:8 row_mask:0xf bank_mask:0xc
    v_add_f32_dpp v20, v24, v24 row_shl:4 row_mask:0xf bank_mask:0x5
    s_nop 1
    v_add_f32_dpp v20, v25, v25 row_shr:4 row_mask:0xf bank_mask:0xa
    s_mov_b32 s78, 32768
    buffer_load_dwordx4 a[100:103], v40, s[40:43], s78 offen offset:1024 nt
    s_waitcnt vmcnt(9)
    v_dot2_f32_bf16 v26, v96, v6, 0
    v_dot2_f32_bf16 v27, v100, v6, 0
    v_dot2_f32_bf16 v26, v97, v7, v26
    v_dot2_f32_bf16 v27, v101, v7, v27
    v_dot2_f32_bf16 v26, v98, v8, v26
    v_dot2_f32_bf16 v27, v102, v8, v27
    v_dot2_f32_bf16 v26, v99, v9, v26
    v_dot2_f32_bf16 v27, v103, v9, v27
    s_nop 1
    v_add_f32_dpp v24, v26, v26 row_ror:8 row_mask:0xf bank_mask:0x3
    s_nop 1
    v_add_f32_dpp v24, v27, v27 row_ror:8 row_mask:0xf bank_mask:0xc
    v_dot2_f32_bf16 v26, v104, v6, 0
    v_dot2_f32_bf16 v27, v108, v6, 0
    v_dot2_f32_bf16 v26, v105, v7, v26
    v_dot2_f32_bf16 v27, v109, v7, v27
    v_dot2_f32_bf16 v26, v106, v8, v26
    v_dot2_f32_bf16 v27, v110, v8, v27
    v_dot2_f32_bf16 v26, v107, v9, v26
    v_dot2_f32_bf16 v27, v111, v9, v27
    s_nop 1
    v_add_f32_dpp v25, v26, v26 row_ror:8 row_mask:0xf bank_mask:0x3
    s_nop 1
    v_add_f32_dpp v25, v27, v27 row_ror:8 row_mask:0xf bank_mask:0xc
    v_add_f32_dpp v21, v24, v24 row_shl:4 row_mask:0xf bank_mask:0x5
    s_nop 1
    v_add_f32_dpp v21, v25, v25 row_shr:4 row_mask:0xf bank_mask:0xa
    v_add_f32_dpp v20, v20, v20 quad_perm:[2,3,0,1] row_mask:0xf bank_mask:0xf
    s_nop 0
    v_add_f32_dpp v21, v21, v21 quad_perm:[2,3,0,1] row_mask:0xf bank_mask:0xf
    v_cndmask_b32 v23, v20, v21, s[94:95]
    v_add_f32_dpp v22, v22, v22 quad_perm:[1,0,3,2] row_mask:0xf bank_mask:0xf
    s_nop 0
    v_add_f32_dpp v23, v23, v23 quad_perm:[1,0,3,2] row_mask:0xf bank_mask:0xf
    v_cndmask_b32 v10, v22, v23, s[96:97]
    v_cvt_pk_bf16_f32 v10, v10, v10
    v_and_b32 v10, 0xffff0000, v10
    v_mul_f32 v10, 1035273459, v10
    v_cvt_pk_bf16_f32 v10, v10, v10
    v_and_b32 v10, 0xffff0000, v10
    v_dot2_f32_bf16 v26, v112, v6, 0
    v_dot2_f32_bf16 v27, v116, v6, 0
    v_dot2_f32_bf16 v26, v113, v7, v26
    v_dot2_f32_bf16 v27, v117, v7, v27
    v_dot2_f32_bf16 v26, v114, v8, v26
    v_dot2_f32_bf16 v27, v118, v8, v27
    v_dot2_f32_bf16 v26, v115, v9, v26
    v_dot2_f32_bf16 v27, v119, v9, v27
    s_nop 1
    v_add_f32_dpp v24, v26, v26 row_ror:8 row_mask:0xf bank_mask:0x3
    s_nop 1
    v_add_f32_dpp v24, v27, v27 row_ror:8 row_mask:0xf bank_mask:0xc
    buffer_load_dwordx4 v[236:239], v1, s[28:31], s81 offen nt
    s_addk_i32 s81, 0x1000
    s_and_b32 s81, s81, s83
    s_waitcnt vmcnt(9)
    v_dot2_f32_bf16 v26, v120, v6, 0
    v_dot2_f32_bf16 v27, v124, v6, 0
    v_dot2_f32_bf16 v26, v121, v7, v26
    v_dot2_f32_bf16 v27, v125, v7, v27
    v_dot2_f32_bf16 v26, v122, v8, v26
    v_dot2_f32_bf16 v27, v126, v8, v27
    v_dot2_f32_bf16 v26, v123, v9, v26
    v_dot2_f32_bf16 v27, v127, v9, v27
    s_nop 1
    v_add_f32_dpp v25, v26, v26 row_ror:8 row_mask:0xf bank_mask:0x3
    s_nop 1
    v_add_f32_dpp v25, v27, v27 row_ror:8 row_mask:0xf bank_mask:0xc
    v_add_f32_dpp v20, v24, v24 row_shl:4 row_mask:0xf bank_mask:0x5
    s_nop 1
    v_add_f32_dpp v20, v25, v25 row_shr:4 row_mask:0xf bank_mask:0xa
    v_dot2_f32_bf16 v26, v128, v6, 0
    v_dot2_f32_bf16 v27, v132, v6, 0
    v_dot2_f32_bf16 v26, v129, v7, v26
    v_dot2_f32_bf16 v27, v133, v7, v27
    v_dot2_f32_bf16 v26, v130, v8, v26
    v_dot2_f32_bf16 v27, v134, v8, v27
    v_dot2_f32_bf16 v26, v131, v9, v26
    v_dot2_f32_bf16 v27, v135, v9, v27
    s_nop 1
    v_add_f32_dpp v24, v26, v26 row_ror:8 row_mask:0xf bank_mask:0x3
    s_nop 1
    v_add_f32_dpp v24, v27, v27 row_ror:8 row_mask:0xf bank_mask:0xc
    v_dot2_f32_bf16 v26, v136, v6, 0
    v_dot2_f32_bf16 v27, v140, v6, 0
    v_dot2_f32_bf16 v26, v137, v7, v26
    v_dot2_f32_bf16 v27, v141, v7, v27
    v_dot2_f32_bf16 v26, v138, v8, v26
    v_dot2_f32_bf16 v27, v142, v8, v27
    v_dot2_f32_bf16 v26, v139, v9, v26
    v_dot2_f32_bf16 v27, v143, v9, v27
    s_nop 1
    v_add_f32_dpp v25, v26, v26 row_ror:8 row_mask:0xf bank_mask:0x3
    s_nop 1
    v_add_f32_dpp v25, v27, v27 row_ror:8 row_mask:0xf bank_mask:0xc
    v_add_f32_dpp v21, v24, v24 row_shl:4 row_mask:0xf bank_mask:0x5
    s_nop 1
    v_add_f32_dpp v21, v25, v25 row_shr:4 row_mask:0xf bank_mask:0xa
    v_add_f32_dpp v20, v20, v20 quad_perm:[2,3,0,1] row_mask:0xf bank_mask:0xf
    s_nop 0
    v_add_f32_dpp v21, v21, v21 quad_perm:[2,3,0,1] row_mask:0xf bank_mask:0xf
    v_cndmask_b32 v22, v20, v21, s[94:95]
    buffer_load_dwordx4 v[240:243], v1, s[28:31], s81 offen nt
    s_addk_i32 s81, 0x1000
    s_and_b32 s81, s81, s83
    s_waitcnt vmcnt(9)
    v_dot2_f32_bf16 v26, v144, v6, 0
    v_dot2_f32_bf16 v27, v148, v6, 0
    v_dot2_f32_bf16 v26, v145, v7, v26
    v_dot2_f32_bf16 v27, v149, v7, v27
    v_dot2_f32_bf16 v26, v146, v8, v26
    v_dot2_f32_bf16 v27, v150, v8, v27
    v_dot2_f32_bf16 v26, v147, v9, v26
    v_dot2_f32_bf16 v27, v151, v9, v27
    s_nop 1
    v_add_f32_dpp v24, v26, v26 row_ror:8 row_mask:0xf bank_mask:0x3
    s_nop 1
    v_add_f32_dpp v24, v27, v27 row_ror:8 row_mask:0xf bank_mask:0xc
    v_dot2_f32_bf16 v26, v152, v6, 0
    v_dot2_f32_bf16 v27, v156, v6, 0
    v_dot2_f32_bf16 v26, v153, v7, v26
    v_dot2_f32_bf16 v27, v157, v7, v27
    v_dot2_f32_bf16 v26, v154, v8, v26
    v_dot2_f32_bf16 v27, v158, v8, v27
    v_dot2_f32_bf16 v26, v155, v9, v26
    v_dot2_f32_bf16 v27, v159, v9, v27
    s_nop 1
    v_add_f32_dpp v25, v26, v26 row_ror:8 row_mask:0xf bank_mask:0x3
    s_nop 1
    v_add_f32_dpp v25, v27, v27 row_ror:8 row_mask:0xf bank_mask:0xc
    v_add_f32_dpp v20, v24, v24 row_shl:4 row_mask:0xf bank_mask:0x5
    s_nop 1
    v_add_f32_dpp v20, v25, v25 row_shr:4 row_mask:0xf bank_mask:0xa
    v_dot2_f32_bf16 v26, v160, v6, 0
    v_dot2_f32_bf16 v27, v164, v6, 0
    v_dot2_f32_bf16 v26, v161, v7, v26
    v_dot2_f32_bf16 v27, v165, v7, v27
    v_dot2_f32_bf16 v26, v162, v8, v26
    v_dot2_f32_bf16 v27, v166, v8, v27
    v_dot2_f32_bf16 v26, v163, v9, v26
    v_dot2_f32_bf16 v27, v167, v9, v27
    s_nop 1
    v_add_f32_dpp v24, v26, v26 row_ror:8 row_mask:0xf bank_mask:0x3
    s_nop 1
    v_add_f32_dpp v24, v27, v27 row_ror:8 row_mask:0xf bank_mask:0xc
    buffer_load_dwordx4 v[244:247], v1, s[28:31], s81 offen nt
    s_addk_i32 s81, 0x1000
    s_and_b32 s81, s81, s83
    s_waitcnt vmcnt(9)
    v_dot2_f32_bf16 v26, v168, v6, 0
    v_dot2_f32_bf16 v27, v172, v6, 0
    v_dot2_f32_bf16 v26, v169, v7, v26
    v_dot2_f32_bf16 v27, v173, v7, v27
    v_dot2_f32_bf16 v26, v170, v8, v26
    v_dot2_f32_bf16 v27, v174, v8, v27
    v_dot2_f32_bf16 v26, v171, v9, v26
    v_dot2_f32_bf16 v27, v175, v9, v27
    s_nop 1
    v_add_f32_dpp v25, v26, v26 row_ror:8 row_mask:0xf bank_mask:0x3
    s_nop 1
    v_add_f32_dpp v25, v27, v27 row_ror:8 row_mask:0xf bank_mask:0xc
    v_add_f32_dpp v21, v24, v24 row_shl:4 row_mask:0xf bank_mask:0x5
    s_nop 1
    v_add_f32_dpp v21, v25, v25 row_shr:4 row_mask:0xf bank_mask:0xa
    v_add_f32_dpp v20, v20, v20 quad_perm:[2,3,0,1] row_mask:0xf bank_mask:0xf
    s_nop 0
    v_add_f32_dpp v21, v21, v21 quad_perm:[2,3,0,1] row_mask:0xf bank_mask:0xf
    v_cndmask_b32 v23, v20, v21, s[94:95]
    v_add_f32_dpp v22, v22, v22 quad_perm:[1,0,3,2] row_mask:0xf bank_mask:0xf
    s_nop 0
    v_add_f32_dpp v23, v23, v23 quad_perm:[1,0,3,2] row_mask:0xf bank_mask:0xf
    v_cndmask_b32 v11, v22, v23, s[96:97]
    v_cvt_pk_bf16_f32 v11, v11, v11
    v_and_b32 v11, 0xffff0000, v11
    v_mul_f32 v11, 1035273459, v11
    v_cvt_pk_bf16_f32 v11, v11, v11
    v_and_b32 v11, 0xffff0000, v11
    v_dot2_f32_bf16 v26, v176, v6, 0
    v_dot2_f32_bf16 v27, v180, v6, 0
    v_dot2_f32_bf16 v26, v177, v7, v26
    v_dot2_f32_bf16 v27, v181, v7, v27
    v_dot2_f32_bf16 v26, v178, v8, v26
    v_dot2_f32_bf16 v27, v182, v8, v27
    v_dot2_f32_bf16 v26, v179, v9, v26
    v_dot2_f32_bf16 v27, v183, v9, v27
    s_nop 1
    v_add_f32_dpp v24, v26, v26 row_ror:8 row_mask:0xf bank_mask:0x3
    s_nop 1
    v_add_f32_dpp v24, v27, v27 row_ror:8 row_mask:0xf bank_mask:0xc
    v_dot2_f32_bf16 v26, v184, v6, 0
    v_dot2_f32_bf16 v27, v188, v6, 0
    v_dot2_f32_bf16 v26, v185, v7, v26
    v_dot2_f32_bf16 v27, v189, v7, v27
    v_dot2_f32_bf16 v26, v186, v8, v26
    v_dot2_f32_bf16 v27, v190, v8, v27
    v_dot2_f32_bf16 v26, v187, v9, v26
    v_dot2_f32_bf16 v27, v191, v9, v27
    s_nop 1
    v_add_f32_dpp v25, v26, v26 row_ror:8 row_mask:0xf bank_mask:0x3
    s_nop 1
    v_add_f32_dpp v25, v27, v27 row_ror:8 row_mask:0xf bank_mask:0xc
    v_add_f32_dpp v20, v24, v24 row_shl:4 row_mask:0xf bank_mask:0x5
    s_nop 1
    v_add_f32_dpp v20, v25, v25 row_shr:4 row_mask:0xf bank_mask:0xa
    s_mov_b32 s78, 32768
    buffer_load_dwordx4 a[104:107], v40, s[40:43], s78 offen offset:2048 nt
    s_waitcnt vmcnt(9)
    v_dot2_f32_bf16 v26, v192, v6, 0
    v_dot2_f32_bf16 v27, v196, v6, 0
    v_dot2_f32_bf16 v26, v193, v7, v26
    v_dot2_f32_bf16 v27, v197, v7, v27
    v_dot2_f32_bf16 v26, v194, v8, v26
    v_dot2_f32_bf16 v27, v198, v8, v27
    v_dot2_f32_bf16 v26, v195, v9, v26
    v_dot2_f32_bf16 v27, v199, v9, v27
    s_nop 1
    v_add_f32_dpp v24, v26, v26 row_ror:8 row_mask:0xf bank_mask:0x3
    s_nop 1
    v_add_f32_dpp v24, v27, v27 row_ror:8 row_mask:0xf bank_mask:0xc
    v_dot2_f32_bf16 v26, v200, v6, 0
    v_dot2_f32_bf16 v27, v204, v6, 0
    v_dot2_f32_bf16 v26, v201, v7, v26
    v_dot2_f32_bf16 v27, v205, v7, v27
    v_dot2_f32_bf16 v26, v202, v8, v26
    v_dot2_f32_bf16 v27, v206, v8, v27
    v_dot2_f32_bf16 v26, v203, v9, v26
    v_dot2_f32_bf16 v27, v207, v9, v27
    s_nop 1
    v_add_f32_dpp v25, v26, v26 row_ror:8 row_mask:0xf bank_mask:0x3
    s_nop 1
    v_add_f32_dpp v25, v27, v27 row_ror:8 row_mask:0xf bank_mask:0xc
    v_add_f32_dpp v21, v24, v24 row_shl:4 row_mask:0xf bank_mask:0x5
    s_nop 1
    v_add_f32_dpp v21, v25, v25 row_shr:4 row_mask:0xf bank_mask:0xa
    v_add_f32_dpp v20, v20, v20 quad_perm:[2,3,0,1] row_mask:0xf bank_mask:0xf
    s_nop 0
    v_add_f32_dpp v21, v21, v21 quad_perm:[2,3,0,1] row_mask:0xf bank_mask:0xf
    v_cndmask_b32 v22, v20, v21, s[94:95]
    v_dot2_f32_bf16 v26, v208, v6, 0
    v_dot2_f32_bf16 v27, v212, v6, 0
    v_dot2_f32_bf16 v26, v209, v7, v26
    v_dot2_f32_bf16 v27, v213, v7, v27
    v_dot2_f32_bf16 v26, v210, v8, v26
    v_dot2_f32_bf16 v27, v214, v8, v27
    v_dot2_f32_bf16 v26, v211, v9, v26
    v_dot2_f32_bf16 v27, v215, v9, v27
    s_nop 1
    v_add_f32_dpp v24, v26, v26 row_ror:8 row_mask:0xf bank_mask:0x3
    s_nop 1
    v_add_f32_dpp v24, v27, v27 row_ror:8 row_mask:0xf bank_mask:0xc
    buffer_load_dwordx4 v[248:251], v1, s[28:31], s81 offen nt
    s_addk_i32 s81, 0x1000
    s_and_b32 s81, s81, s83
    s_waitcnt vmcnt(9)
    v_dot2_f32_bf16 v26, v216, v6, 0
    v_dot2_f32_bf16 v27, v220, v6, 0
    v_dot2_f32_bf16 v26, v217, v7, v26
    v_dot2_f32_bf16 v27, v221, v7, v27
    v_dot2_f32_bf16 v26, v218, v8, v26
    v_dot2_f32_bf16 v27, v222, v8, v27
    v_dot2_f32_bf16 v26, v219, v9, v26
    v_dot2_f32_bf16 v27, v223, v9, v27
    s_nop 1
    v_add_f32_dpp v25, v26, v26 row_ror:8 row_mask:0xf bank_mask:0x3
    s_nop 1
    v_add_f32_dpp v25, v27, v27 row_ror:8 row_mask:0xf bank_mask:0xc
    v_add_f32_dpp v20, v24, v24 row_shl:4 row_mask:0xf bank_mask:0x5
    s_nop 1
    v_add_f32_dpp v20, v25, v25 row_shr:4 row_mask:0xf bank_mask:0xa
    buffer_load_dwordx4 v[252:255], v1, s[28:31], s81 offen nt
    s_addk_i32 s81, 0x1000
    s_and_b32 s81, s81, s83
    s_waitcnt vmcnt(9)
    buffer_load_dwordx4 v[48:51], v1, s[28:31], s81 offen nt
    s_addk_i32 s81, 0x1000
    s_and_b32 s81, s81, s83
    s_waitcnt vmcnt(9)
    v_dot2_f32_bf16 v26, v224, v6, 0
    v_dot2_f32_bf16 v27, v228, v6, 0
    v_dot2_f32_bf16 v26, v225, v7, v26
    v_dot2_f32_bf16 v27, v229, v7, v27
    v_dot2_f32_bf16 v26, v226, v8, v26
    v_dot2_f32_bf16 v27, v230, v8, v27
    v_dot2_f32_bf16 v26, v227, v9, v26
    v_dot2_f32_bf16 v27, v231, v9, v27
    s_nop 1
    v_add_f32_dpp v24, v26, v26 row_ror:8 row_mask:0xf bank_mask:0x3
    s_nop 1
    v_add_f32_dpp v24, v27, v27 row_ror:8 row_mask:0xf bank_mask:0xc
    s_mov_b32 s78, 32768
    buffer_load_dwordx4 a[108:111], v40, s[40:43], s78 offen offset:3072 nt
    s_waitcnt vmcnt(9)
    buffer_load_dwordx4 v[52:55], v1, s[28:31], s81 offen nt
    s_addk_i32 s81, 0x1000
    s_and_b32 s81, s81, s83
    s_waitcnt vmcnt(9)
    buffer_load_dwordx4 v[56:59], v1, s[28:31], s81 offen nt
    s_addk_i32 s81, 0x1000
    s_and_b32 s81, s81, s83
    s_waitcnt vmcnt(9)
    v_dot2_f32_bf16 v26, v232, v6, 0
    v_dot2_f32_bf16 v27, v236, v6, 0
    v_dot2_f32_bf16 v26, v233, v7, v26
    v_dot2_f32_bf16 v27, v237, v7, v27
    v_dot2_f32_bf16 v26, v234, v8, v26
    v_dot2_f32_bf16 v27, v238, v8, v27
    v_dot2_f32_bf16 v26, v235, v9, v26
    v_dot2_f32_bf16 v27, v239, v9, v27
    s_nop 1
    v_add_f32_dpp v25, v26, v26 row_ror:8 row_mask:0xf bank_mask:0x3
    s_nop 1
    v_add_f32_dpp v25, v27, v27 row_ror:8 row_mask:0xf bank_mask:0xc
    v_add_f32_dpp v21, v24, v24 row_shl:4 row_mask:0xf bank_mask:0x5
    s_nop 1
    v_add_f32_dpp v21, v25, v25 row_shr:4 row_mask:0xf bank_mask:0xa
    v_add_f32_dpp v20, v20, v20 quad_perm:[2,3,0,1] row_mask:0xf bank_mask:0xf
    s_nop 0
    v_add_f32_dpp v21, v21, v21 quad_perm:[2,3,0,1] row_mask:0xf bank_mask:0xf
    v_cndmask_b32 v23, v20, v21, s[94:95]
    v_add_f32_dpp v22, v22, v22 quad_perm:[1,0,3,2] row_mask:0xf bank_mask:0xf
    s_nop 0
    v_add_f32_dpp v23, v23, v23 quad_perm:[1,0,3,2] row_mask:0xf bank_mask:0xf
    v_cndmask_b32 v12, v22, v23, s[96:97]
    v_cvt_pk_bf16_f32 v12, v12, v12
    v_and_b32 v12, 0xffff0000, v12
    v_mul_f32 v12, 1035273459, v12
    v_cvt_pk_bf16_f32 v12, v12, v12
    v_and_b32 v12, 0xffff0000, v12
    buffer_load_dwordx4 v[60:63], v1, s[28:31], s81 offen nt
    s_addk_i32 s81, 0x1000
    s_and_b32 s81, s81, s83
    s_waitcnt vmcnt(9)
    s_mov_b32 s78, 36864
    buffer_load_dwordx4 a[112:115], v40, s[40:43], s78 offen offset:0 nt
    s_waitcnt vmcnt(9)
    v_dot2_f32_bf16 v26, v240, v6, 0
    v_dot2_f32_bf16 v27, v244, v6, 0
    v_dot2_f32_bf16 v26, v241, v7, v26
    v_dot2_f32_bf16 v27, v245, v7, v27
    v_dot2_f32_bf16 v26, v242, v8, v26
    v_dot2_f32_bf16 v27, v246, v8, v27
    v_dot2_f32_bf16 v26, v243, v9, v26
    v_dot2_f32_bf16 v27, v247, v9, v27
    s_nop 1
    v_add_f32_dpp v24, v26, v26 row_ror:8 row_mask:0xf bank_mask:0x3
    s_nop 1
    v_add_f32_dpp v24, v27, v27 row_ror:8 row_mask:0xf bank_mask:0xc
    buffer_load_dwordx4 a[236:239], v42, s[56:59], 0 offen
    s_mov_b32 s78, 34816
    buffer_load_dwordx4 a[240:243], v42, s[56:59], s78 offen
    s_waitcnt vmcnt(9)
    buffer_load_dwordx4 v[64:67], v1, s[28:31], s81 offen nt
    s_addk_i32 s81, 0x1000
    s_and_b32 s81, s81, s83
    s_waitcnt vmcnt(9)
    v_dot2_f32_bf16 v26, v248, v6, 0
    v_dot2_f32_bf16 v27, v252, v6, 0
    v_dot2_f32_bf16 v26, v249, v7, v26
    v_dot2_f32_bf16 v27, v253, v7, v27
    v_dot2_f32_bf16 v26, v250, v8, v26
    v_dot2_f32_bf16 v27, v254, v8, v27
    v_dot2_f32_bf16 v26, v251, v9, v26
    v_dot2_f32_bf16 v27, v255, v9, v27
    s_nop 1
    v_add_f32_dpp v25, v26, v26 row_ror:8 row_mask:0xf bank_mask:0x3
    s_nop 1
    v_add_f32_dpp v25, v27, v27 row_ror:8 row_mask:0xf bank_mask:0xc
    v_add_f32_dpp v20, v24, v24 row_shl:4 row_mask:0xf bank_mask:0x5
    s_nop 1
    v_add_f32_dpp v20, v25, v25 row_shr:4 row_mask:0xf bank_mask:0xa
    buffer_load_dwordx4 v[68:71], v1, s[28:31], s81 offen nt
    s_addk_i32 s81, 0x1000
    s_and_b32 s81, s81, s83
    s_waitcnt vmcnt(9)
    s_mov_b32 s78, 36864
    buffer_load_dwordx4 a[116:119], v40, s[40:43], s78 offen offset:1024 nt
    s_waitcnt vmcnt(9)
    buffer_load_dword a247, v37, s[56:59], 0 offen nt
    s_waitcnt vmcnt(9)
    v_dot2_f32_bf16 v26, v48, v6, 0
    v_dot2_f32_bf16 v27, v52, v6, 0
    v_dot2_f32_bf16 v26, v49, v7, v26
    v_dot2_f32_bf16 v27, v53, v7, v27
    v_dot2_f32_bf16 v26, v50, v8, v26
    v_dot2_f32_bf16 v27, v54, v8, v27
    v_dot2_f32_bf16 v26, v51, v9, v26
    v_dot2_f32_bf16 v27, v55, v9, v27
    s_nop 1
    v_add_f32_dpp v24, v26, v26 row_ror:8 row_mask:0xf bank_mask:0x3
    s_nop 1
    v_add_f32_dpp v24, v27, v27 row_ror:8 row_mask:0xf bank_mask:0xc
    buffer_load_dwordx4 v[72:75], v1, s[28:31], s81 offen nt
    s_addk_i32 s81, 0x1000
    s_and_b32 s81, s81, s83
    s_waitcnt vmcnt(9)
    buffer_load_dwordx4 v[76:79], v1, s[28:31], s81 offen nt
    s_addk_i32 s81, 0x1000
    s_and_b32 s81, s81, s83
    s_waitcnt vmcnt(9)
    v_dot2_f32_bf16 v26, v56, v6, 0
    v_dot2_f32_bf16 v27, v60, v6, 0
    v_dot2_f32_bf16 v26, v57, v7, v26
    v_dot2_f32_bf16 v27, v61, v7, v27
    v_dot2_f32_bf16 v26, v58, v8, v26
    v_dot2_f32_bf16 v27, v62, v8, v27
    v_dot2_f32_bf16 v26, v59, v9, v26
    v_dot2_f32_bf16 v27, v63, v9, v27
    s_nop 1
    v_add_f32_dpp v25, v26, v26 row_ror:8 row_mask:0xf bank_mask:0x3
    s_nop 1
    v_add_f32_dpp v25, v27, v27 row_ror:8 row_mask:0xf bank_mask:0xc
    v_add_f32_dpp v21, v24, v24 row_shl:4 row_mask:0xf bank_mask:0x5
    s_nop 1
    v_add_f32_dpp v21, v25, v25 row_shr:4 row_mask:0xf bank_mask:0xa
    v_add_f32_dpp v20, v20, v20 quad_perm:[2,3,0,1] row_mask:0xf bank_mask:0xf
    s_nop 0
    v_add_f32_dpp v21, v21, v21 quad_perm:[2,3,0,1] row_mask:0xf bank_mask:0xf
    v_cndmask_b32 v22, v20, v21, s[94:95]
    buffer_load_dwordx4 v[80:83], v1, s[28:31], s81 offen nt
    s_addk_i32 s81, 0x1000
    s_and_b32 s81, s81, s83
    s_waitcnt vmcnt(9)
    s_mov_b32 s78, 36864
    buffer_load_dwordx4 a[120:123], v40, s[40:43], s78 offen offset:2048 nt
    s_waitcnt vmcnt(9)
    buffer_load_dwordx4 v[84:87], v1, s[28:31], s81 offen nt
    s_addk_i32 s81, 0x1000
    s_and_b32 s81, s81, s83
    s_waitcnt vmcnt(9)
    buffer_load_dwordx4 v[88:91], v1, s[28:31], s81 offen nt
    s_addk_i32 s81, 0x1000
    s_and_b32 s81, s81, s83
    s_waitcnt vmcnt(9)
    buffer_load_dwordx4 v[92:95], v1, s[28:31], s81 offen nt
    s_addk_i32 s81, 0x1000
    s_and_b32 s81, s81, s83
    s_waitcnt vmcnt(9)
    v_dot2_f32_bf16 v26, v64, v6, 0
    v_dot2_f32_bf16 v27, v68, v6, 0
    v_dot2_f32_bf16 v26, v65, v7, v26
    v_dot2_f32_bf16 v27, v69, v7, v27
    v_dot2_f32_bf16 v26, v66, v8, v26
    v_dot2_f32_bf16 v27, v70, v8, v27
    v_dot2_f32_bf16 v26, v67, v9, v26
    v_dot2_f32_bf16 v27, v71, v9, v27
    s_nop 1
    v_add_f32_dpp v24, v26, v26 row_ror:8 row_mask:0xf bank_mask:0x3
    s_nop 1
    v_add_f32_dpp v24, v27, v27 row_ror:8 row_mask:0xf bank_mask:0xc
    s_mov_b32 s78, 36864
    buffer_load_dwordx4 a[124:127], v40, s[40:43], s78 offen offset:3072 nt
    s_waitcnt vmcnt(9)
    buffer_load_dwordx4 a[0:3], v1, s[32:35], s82 offen nt
    s_addk_i32 s82, 0x1000
    s_and_b32 s82, s82, s83
    s_waitcnt vmcnt(9)
    buffer_load_dwordx4 a[4:7], v1, s[32:35], s82 offen nt
    s_addk_i32 s82, 0x1000
    s_and_b32 s82, s82, s83
    s_waitcnt vmcnt(9)
    buffer_load_dwordx4 a[8:11], v1, s[32:35], s82 offen nt
    s_addk_i32 s82, 0x1000
    s_and_b32 s82, s82, s83
    s_waitcnt vmcnt(9)
    v_dot2_f32_bf16 v26, v72, v6, 0
    v_dot2_f32_bf16 v27, v76, v6, 0
    v_dot2_f32_bf16 v26, v73, v7, v26
    v_dot2_f32_bf16 v27, v77, v7, v27
    v_dot2_f32_bf16 v26, v74, v8, v26
    v_dot2_f32_bf16 v27, v78, v8, v27
    v_dot2_f32_bf16 v26, v75, v9, v26
    v_dot2_f32_bf16 v27, v79, v9, v27
    s_nop 1
    v_add_f32_dpp v25, v26, v26 row_ror:8 row_mask:0xf bank_mask:0x3
    s_nop 1
    v_add_f32_dpp v25, v27, v27 row_ror:8 row_mask:0xf bank_mask:0xc
    v_add_f32_dpp v20, v24, v24 row_shl:4 row_mask:0xf bank_mask:0x5
    s_nop 1
    v_add_f32_dpp v20, v25, v25 row_shr:4 row_mask:0xf bank_mask:0xa
    s_mov_b32 s78, 65536
    buffer_load_dwordx4 a[128:131], v40, s[40:43], s78 offen offset:0 nt
    s_waitcnt vmcnt(9)
    buffer_load_dwordx4 a[12:15], v1, s[32:35], s82 offen nt
    s_addk_i32 s82, 0x1000
    s_and_b32 s82, s82, s83
    s_waitcnt vmcnt(9)
    buffer_load_dwordx4 a[16:19], v1, s[32:35], s82 offen nt
    s_addk_i32 s82, 0x1000
    s_and_b32 s82, s82, s83
    s_waitcnt vmcnt(9)
    v_dot2_f32_bf16 v26, v80, v6, 0
    v_dot2_f32_bf16 v27, v84, v6, 0
    v_dot2_f32_bf16 v26, v81, v7, v26
    v_dot2_f32_bf16 v27, v85, v7, v27
    v_dot2_f32_bf16 v26, v82, v8, v26
    v_dot2_f32_bf16 v27, v86, v8, v27
    v_dot2_f32_bf16 v26, v83, v9, v26
    v_dot2_f32_bf16 v27, v87, v9, v27
    s_nop 1
    v_add_f32_dpp v24, v26, v26 row_ror:8 row_mask:0xf bank_mask:0x3
    s_nop 1
    v_add_f32_dpp v24, v27, v27 row_ror:8 row_mask:0xf bank_mask:0xc
    s_mov_b32 s78, 65536
    buffer_load_dwordx4 a[132:135], v40, s[40:43], s78 offen offset:1024 nt
    s_waitcnt vmcnt(9)
    buffer_load_dwordx4 a[20:23], v1, s[32:35], s82 offen nt
    s_addk_i32 s82, 0x1000
    s_and_b32 s82, s82, s83
    s_waitcnt vmcnt(9)
    v_dot2_f32_bf16 v26, v88, v6, 0
    v_dot2_f32_bf16 v27, v92, v6, 0
    v_dot2_f32_bf16 v26, v89, v7, v26
    v_dot2_f32_bf16 v27, v93, v7, v27
    v_dot2_f32_bf16 v26, v90, v8, v26
    v_dot2_f32_bf16 v27, v94, v8, v27
    v_dot2_f32_bf16 v26, v91, v9, v26
    v_dot2_f32_bf16 v27, v95, v9, v27
    s_nop 1
    v_add_f32_dpp v25, v26, v26 row_ror:8 row_mask:0xf bank_mask:0x3
    s_nop 1
    v_add_f32_dpp v25, v27, v27 row_ror:8 row_mask:0xf bank_mask:0xc
    v_add_f32_dpp v21, v24, v24 row_shl:4 row_mask:0xf bank_mask:0x5
    s_nop 1
    v_add_f32_dpp v21, v25, v25 row_shr:4 row_mask:0xf bank_mask:0xa
    v_add_f32_dpp v20, v20, v20 quad_perm:[2,3,0,1] row_mask:0xf bank_mask:0xf
    s_nop 0
    v_add_f32_dpp v21, v21, v21 quad_perm:[2,3,0,1] row_mask:0xf bank_mask:0xf
    v_cndmask_b32 v23, v20, v21, s[94:95]
    v_add_f32_dpp v22, v22, v22 quad_perm:[1,0,3,2] row_mask:0xf bank_mask:0xf
    s_nop 0
    v_add_f32_dpp v23, v23, v23 quad_perm:[1,0,3,2] row_mask:0xf bank_mask:0xf
    v_cndmask_b32 v13, v22, v23, s[96:97]
    v_cvt_pk_bf16_f32 v13, v13, v13
    v_and_b32 v13, 0xffff0000, v13
    v_mul_f32 v13, 1035273459, v13
    v_cvt_pk_bf16_f32 v13, v13, v13
    v_and_b32 v13, 0xffff0000, v13
    v_max3_f32 v34, v10, v11, v12
    v_max_f32 v34, v34, v13
    s_nop 1
    v_max_f32_dpp v34, v34, v34 row_ror:8 row_mask:0xf bank_mask:0xf
    s_nop 1
    v_max_f32_dpp v34, v34, v34 row_ror:4 row_mask:0xf bank_mask:0xf
    s_nop 1
    v_max_f32_dpp v34, v34, v34 row_ror:2 row_mask:0xf bank_mask:0xf
    s_nop 1
    v_max_f32_dpp v34, v34, v34 row_ror:1 row_mask:0xf bank_mask:0xf
    v_mov_b32 v30, v34
    s_nop 1
    v_permlane16_swap_b32 v34, v30
    v_max_f32 v34, v34, v30
    v_mov_b32 v30, v34
    s_nop 1
    v_permlane32_swap_b32 v34, v30
    v_max_f32 v34, v34, v30
    v_sub_f32 v10, v10, v34
    v_sub_f32 v11, v11, v34
    v_sub_f32 v12, v12, v34
    v_sub_f32 v13, v13, v34
    v_mul_f32 v10, 1069066811, v10
    v_mul_f32 v11, 1069066811, v11
    v_mul_f32 v12, 1069066811, v12
    v_mul_f32 v13, 1069066811, v13
    v_exp_f32 v10, v10
    v_exp_f32 v11, v11
    v_exp_f32 v12, v12
    v_exp_f32 v13, v13
    v_cvt_pk_bf16_f32 v6, v10, v10
    v_cvt_pk_bf16_f32 v7, v11, v11
    v_cvt_pk_bf16_f32 v8, v12, v12
    v_cvt_pk_bf16_f32 v9, v13, v13
    v_add_f32 v35, v10, v11
    v_add_f32 v30, v12, v13
    v_add_f32 v35, v35, v30
    v_and_b32_dpp v16, v6, v2 row_newbcast:0 row_mask:0xf bank_mask:0xf
    v_and_b32_dpp v17, v6, v3 row_newbcast:0 row_mask:0xf bank_mask:0xf
    v_and_b32_dpp v18, v6, v4 row_newbcast:0 row_mask:0xf bank_mask:0xf
    v_and_b32_dpp v19, v6, v5 row_newbcast:0 row_mask:0xf bank_mask:0xf
    v_add_f32_dpp v35, v35, v35 row_ror:8 row_mask:0xf bank_mask:0xf
    s_nop 1
    v_add_f32_dpp v35, v35, v35 row_ror:4 row_mask:0xf bank_mask:0xf
    s_nop 1
    v_add_f32_dpp v35, v35, v35 row_ror:2 row_mask:0xf bank_mask:0xf
    s_nop 1
    v_add_f32_dpp v35, v35, v35 row_ror:1 row_mask:0xf bank_mask:0xf
    v_mov_b32 v30, v35
    s_nop 1
    v_permlane16_swap_b32 v35, v30
    v_add_f32 v35, v35, v30
    v_mov_b32 v30, v35
    s_nop 1
    v_permlane32_swap_b32 v35, v30
    v_add_f32 v35, v35, v30
    v_bfi_b32 v30, s92, v0, v34
    v_bfi_b32 v31, s92, v0, v35
    v_mov_b32 v32, s0
    v_mov_b32 v33, s86
    buffer_store_dwordx4 v[30:33], v37, s[56:59], 0 offen
    buffer_load_dwordx4 a[24:27], v1, s[32:35], s82 offen nt
    s_addk_i32 s82, 0x1000
    s_and_b32 s82, s82, s83
    s_waitcnt vmcnt(9)
    v_mfma_f32_16x16x32_bf16 v[24:27], v[16:19], a[0:3], 0
    v_and_b32_dpp v20, v6, v2 row_newbcast:8 row_mask:0xf bank_mask:0xf
    v_and_b32_dpp v21, v6, v3 row_newbcast:8 row_mask:0xf bank_mask:0xf
    v_and_b32_dpp v22, v6, v4 row_newbcast:8 row_mask:0xf bank_mask:0xf
    v_and_b32_dpp v23, v6, v5 row_newbcast:8 row_mask:0xf bank_mask:0xf
    buffer_load_dwordx4 a[28:31], v1, s[32:35], s82 offen nt
    s_addk_i32 s82, 0x1000
    s_and_b32 s82, s82, s83
    s_waitcnt vmcnt(9)
    v_mfma_f32_16x16x32_bf16 v[24:27], v[20:23], a[4:7], v[24:27]
    v_and_b32_dpp v16, v6, v2 row_newbcast:4 row_mask:0xf bank_mask:0xf
    v_and_b32_dpp v17, v6, v3 row_newbcast:4 row_mask:0xf bank_mask:0xf
    v_and_b32_dpp v18, v6, v4 row_newbcast:4 row_mask:0xf bank_mask:0xf
    v_and_b32_dpp v19, v6, v5 row_newbcast:4 row_mask:0xf bank_mask:0xf
    v_accvgpr_read_b32 v64, a64
    v_accvgpr_read_b32 v65, a65
    v_accvgpr_read_b32 v66, a66
    v_accvgpr_read_b32 v67, a67
    v_accvgpr_read_b32 v68, a68
    v_accvgpr_read_b32 v69, a69
    v_accvgpr_read_b32 v70, a70
    v_accvgpr_read_b32 v71, a71
    v_perm_b32 v128, v68, v64, s88
    v_perm_b32 v144, v68, v64, s89
    v_perm_b32 v160, v69, v65, s88
    v_perm_b32 v176, v69, v65, s89
    v_perm_b32 v192, v70, v66, s88
    v_perm_b32 v208, v70, v66, s89
    v_perm_b32 v224, v71, v67, s88
    v_perm_b32 v240, v71, v67, s89
    s_mov_b32 s78, 65536
    buffer_load_dwordx4 a[136:139], v40, s[40:43], s78 offen offset:2048 nt
    s_waitcnt vmcnt(9)
    v_mfma_f32_16x16x32_bf16 v[24:27], v[16:19], a[8:11], v[24:27]
    v_and_b32_dpp v20, v6, v2 row_newbcast:12 row_mask:0xf bank_mask:0xf
    v_and_b32_dpp v21, v6, v3 row_newbcast:12 row_mask:0xf bank_mask:0xf
    v_and_b32_dpp v22, v6, v4 row_newbcast:12 row_mask:0xf bank_mask:0xf
    v_and_b32_dpp v23, v6, v5 row_newbcast:12 row_mask:0xf bank_mask:0xf
    buffer_load_dwordx4 a[32:35], v1, s[32:35], s82 offen nt
    s_addk_i32 s82, 0x1000
    s_and_b32 s82, s82, s83
    s_waitcnt vmcnt(9)
    buffer_load_dwordx4 a[36:39], v1, s[32:35], s82 offen nt
    s_addk_i32 s82, 0x1000
    s_and_b32 s82, s82, s83
    s_waitcnt vmcnt(9)
    v_mfma_f32_16x16x32_bf16 v[24:27], v[20:23], a[12:15], v[24:27]
    v_and_b32_dpp v16, v6, v2 row_newbcast:2 row_mask:0xf bank_mask:0xf
    v_and_b32_dpp v17, v6, v3 row_newbcast:2 row_mask:0xf bank_mask:0xf
    v_and_b32_dpp v18, v6, v4 row_newbcast:2 row_mask:0xf bank_mask:0xf
    v_and_b32_dpp v19, v6, v5 row_newbcast:2 row_mask:0xf bank_mask:0xf
    buffer_load_dwordx4 a[40:43], v1, s[32:35], s82 offen nt
    s_addk_i32 s82, 0x1000
    s_and_b32 s82, s82, s83
    s_waitcnt vmcnt(9)
    v_mfma_f32_16x16x32_bf16 v[24:27], v[16:19], a[16:19], v[24:27]
    v_and_b32_dpp v20, v6, v2 row_newbcast:10 row_mask:0xf bank_mask:0xf
    v_and_b32_dpp v21, v6, v3 row_newbcast:10 row_mask:0xf bank_mask:0xf
    v_and_b32_dpp v22, v6, v4 row_newbcast:10 row_mask:0xf bank_mask:0xf
    v_and_b32_dpp v23, v6, v5 row_newbcast:10 row_mask:0xf bank_mask:0xf
    v_accvgpr_read_b32 v64, a72
    v_accvgpr_read_b32 v65, a73
    v_accvgpr_read_b32 v66, a74
    v_accvgpr_read_b32 v67, a75
    v_accvgpr_read_b32 v68, a76
    v_accvgpr_read_b32 v69, a77
    v_accvgpr_read_b32 v70, a78
    v_accvgpr_read_b32 v71, a79
    v_perm_b32 v129, v68, v64, s88
    v_perm_b32 v145, v68, v64, s89
    v_perm_b32 v161, v69, v65, s88
    v_perm_b32 v177, v69, v65, s89
    v_perm_b32 v193, v70, v66, s88
    v_perm_b32 v209, v70, v66, s89
    v_perm_b32 v225, v71, v67, s88
    v_perm_b32 v241, v71, v67, s89
    s_mov_b32 s78, 65536
    buffer_load_dwordx4 a[140:143], v40, s[40:43], s78 offen offset:3072 nt
    s_waitcnt vmcnt(9)
    buffer_load_dwordx4 a[44:47], v1, s[32:35], s82 offen nt
    s_addk_i32 s82, 0x1000
    s_and_b32 s82, s82, s83
    s_waitcnt vmcnt(9)
    v_mfma_f32_16x16x32_bf16 v[24:27], v[20:23], a[20:23], v[24:27]
    v_and_b32_dpp v16, v6, v2 row_newbcast:6 row_mask:0xf bank_mask:0xf
    v_and_b32_dpp v17, v6, v3 row_newbcast:6 row_mask:0xf bank_mask:0xf
    v_and_b32_dpp v18, v6, v4 row_newbcast:6 row_mask:0xf bank_mask:0xf
    v_and_b32_dpp v19, v6, v5 row_newbcast:6 row_mask:0xf bank_mask:0xf
    buffer_load_dwordx4 a[48:51], v1, s[32:35], s82 offen nt
    s_addk_i32 s82, 0x1000
    s_and_b32 s82, s82, s83
    s_waitcnt vmcnt(9)
    buffer_load_dwordx4 a[52:55], v1, s[32:35], s82 offen nt
    s_addk_i32 s82, 0x1000
    s_and_b32 s82, s82, s83
    s_waitcnt vmcnt(9)
    v_mfma_f32_16x16x32_bf16 v[24:27], v[16:19], a[24:27], v[24:27]
    v_and_b32_dpp v20, v6, v2 row_newbcast:14 row_mask:0xf bank_mask:0xf
    v_and_b32_dpp v21, v6, v3 row_newbcast:14 row_mask:0xf bank_mask:0xf
    v_and_b32_dpp v22, v6, v4 row_newbcast:14 row_mask:0xf bank_mask:0xf
    v_and_b32_dpp v23, v6, v5 row_newbcast:14 row_mask:0xf bank_mask:0xf
    s_mov_b32 s78, 69632
    buffer_load_dwordx4 a[144:147], v40, s[40:43], s78 offen offset:0 nt
    s_waitcnt vmcnt(9)
    v_mfma_f32_16x16x32_bf16 v[24:27], v[20:23], a[28:31], v[24:27]
    v_and_b32_dpp v16, v6, v2 row_newbcast:1 row_mask:0xf bank_mask:0xf
    v_and_b32_dpp v17, v6, v3 row_newbcast:1 row_mask:0xf bank_mask:0xf
    v_and_b32_dpp v18, v6, v4 row_newbcast:1 row_mask:0xf bank_mask:0xf
    v_and_b32_dpp v19, v6, v5 row_newbcast:1 row_mask:0xf bank_mask:0xf
    v_accvgpr_read_b32 v64, a80
    v_accvgpr_read_b32 v65, a81
    v_accvgpr_read_b32 v66, a82
    v_accvgpr_read_b32 v67, a83
    v_accvgpr_read_b32 v68, a84
    v_accvgpr_read_b32 v69, a85
    v_accvgpr_read_b32 v70, a86
    v_accvgpr_read_b32 v71, a87
    v_perm_b32 v130, v68, v64, s88
    v_perm_b32 v146, v68, v64, s89
    v_perm_b32 v162, v69, v65, s88
    v_perm_b32 v178, v69, v65, s89
    v_perm_b32 v194, v70, v66, s88
    v_perm_b32 v210, v70, v66, s89
    v_perm_b32 v226, v71, v67, s88
    v_perm_b32 v242, v71, v67, s89
    buffer_load_dwordx4 a[56:59], v1, s[32:35], s82 offen nt
    s_addk_i32 s82, 0x1000
    s_and_b32 s82, s82, s83
    s_waitcnt vmcnt(9)
    buffer_load_dwordx4 v[80:83], v41, s[48:51], 0 offen offset:0 nt
    s_waitcnt vmcnt(9)
    v_mfma_f32_16x16x32_bf16 v[24:27], v[16:19], a[32:35], v[24:27]
    v_and_b32_dpp v20, v6, v2 row_newbcast:9 row_mask:0xf bank_mask:0xf
    v_and_b32_dpp v21, v6, v3 row_newbcast:9 row_mask:0xf bank_mask:0xf
    v_and_b32_dpp v22, v6, v4 row_newbcast:9 row_mask:0xf bank_mask:0xf
    v_and_b32_dpp v23, v6, v5 row_newbcast:9 row_mask:0xf bank_mask:0xf
    buffer_load_dwordx4 a[60:63], v1, s[32:35], s82 offen nt
    s_addk_i32 s82, 0x1000
    s_and_b32 s82, s82, s83
    s_waitcnt vmcnt(9)
    v_mfma_f32_16x16x32_bf16 v[24:27], v[20:23], a[36:39], v[24:27]
    v_and_b32_dpp v16, v6, v2 row_newbcast:5 row_mask:0xf bank_mask:0xf
    v_and_b32_dpp v17, v6, v3 row_newbcast:5 row_mask:0xf bank_mask:0xf
    v_and_b32_dpp v18, v6, v4 row_newbcast:5 row_mask:0xf bank_mask:0xf
    v_and_b32_dpp v19, v6, v5 row_newbcast:5 row_mask:0xf bank_mask:0xf
    s_mov_b32 s78, 69632
    buffer_load_dwordx4 a[148:151], v40, s[40:43], s78 offen offset:1024 nt
    s_waitcnt vmcnt(9)
    v_mfma_f32_16x16x32_bf16 v[24:27], v[16:19], a[40:43], v[24:27]
    v_and_b32_dpp v20, v6, v2 row_newbcast:13 row_mask:0xf bank_mask:0xf
    v_and_b32_dpp v21, v6, v3 row_newbcast:13 row_mask:0xf bank_mask:0xf
    v_and_b32_dpp v22, v6, v4 row_newbcast:13 row_mask:0xf bank_mask:0xf
    v_and_b32_dpp v23, v6, v5 row_newbcast:13 row_mask:0xf bank_mask:0xf
    v_accvgpr_read_b32 v64, a88
    v_accvgpr_read_b32 v65, a89
    v_accvgpr_read_b32 v66, a90
    v_accvgpr_read_b32 v67, a91
    v_accvgpr_read_b32 v68, a92
    v_accvgpr_read_b32 v69, a93
    v_accvgpr_read_b32 v70, a94
    v_accvgpr_read_b32 v71, a95
    v_perm_b32 v131, v68, v64, s88
    v_perm_b32 v147, v68, v64, s89
    v_perm_b32 v163, v69, v65, s88
    v_perm_b32 v179, v69, v65, s89
    v_perm_b32 v195, v70, v66, s88
    v_perm_b32 v211, v70, v66, s89
    v_perm_b32 v227, v71, v67, s88
    v_perm_b32 v243, v71, v67, s89
    buffer_load_dwordx4 v[84:87], v41, s[48:51], 0 offen offset:1024 nt
    s_waitcnt vmcnt(9)
    buffer_load_dwordx4 a[0:3], v1, s[32:35], s82 offen nt
    s_addk_i32 s82, 0x1000
    s_and_b32 s82, s82, s83
    s_waitcnt vmcnt(9)
    v_mfma_f32_16x16x32_bf16 v[24:27], v[20:23], a[44:47], v[24:27]
    v_and_b32_dpp v16, v6, v2 row_newbcast:3 row_mask:0xf bank_mask:0xf
    v_and_b32_dpp v17, v6, v3 row_newbcast:3 row_mask:0xf bank_mask:0xf
    v_and_b32_dpp v18, v6, v4 row_newbcast:3 row_mask:0xf bank_mask:0xf
    v_and_b32_dpp v19, v6, v5 row_newbcast:3 row_mask:0xf bank_mask:0xf
    buffer_load_dwordx4 v[88:91], v41, s[48:51], 0 offen offset:2048 nt
    s_waitcnt vmcnt(9)
    v_mfma_f32_16x16x32_bf16 v[24:27], v[16:19], a[48:51], v[24:27]
    v_and_b32_dpp v20, v6, v2 row_newbcast:11 row_mask:0xf bank_mask:0xf
    v_and_b32_dpp v21, v6, v3 row_newbcast:11 row_mask:0xf bank_mask:0xf
    v_and_b32_dpp v22, v6, v4 row_newbcast:11 row_mask:0xf bank_mask:0xf
    v_and_b32_dpp v23, v6, v5 row_newbcast:11 row_mask:0xf bank_mask:0xf
    buffer_load_dwordx4 a[4:7], v1, s[32:35], s82 offen nt
    s_addk_i32 s82, 0x1000
    s_and_b32 s82, s82, s83
    s_waitcnt vmcnt(9)
    v_mfma_f32_16x16x32_bf16 v[24:27], v[20:23], a[52:55], v[24:27]
    v_and_b32_dpp v16, v6, v2 row_newbcast:7 row_mask:0xf bank_mask:0xf
    v_and_b32_dpp v17, v6, v3 row_newbcast:7 row_mask:0xf bank_mask:0xf
    v_and_b32_dpp v18, v6, v4 row_newbcast:7 row_mask:0xf bank_mask:0xf
    v_and_b32_dpp v19, v6, v5 row_newbcast:7 row_mask:0xf bank_mask:0xf
    v_accvgpr_read_b32 v64, a96
    v_accvgpr_read_b32 v65, a97
    v_accvgpr_read_b32 v66, a98
    v_accvgpr_read_b32 v67, a99
    v_accvgpr_read_b32 v68, a100
    v_accvgpr_read_b32 v69, a101
    v_accvgpr_read_b32 v70, a102
    v_accvgpr_read_b32 v71, a103
    v_perm_b32 v132, v68, v64, s88
    v_perm_b32 v148, v68, v64, s89
    v_perm_b32 v164, v69, v65, s88
    v_perm_b32 v180, v69, v65, s89
    v_perm_b32 v196, v70, v66, s88
    v_perm_b32 v212, v70, v66, s89
    v_perm_b32 v228, v71, v67, s88
    v_perm_b32 v244, v71, v67, s89
    buffer_load_dwordx4 v[92:95], v41, s[48:51], 0 offen offset:3072 nt
    s_waitcnt vmcnt(9)
    buffer_load_dwordx4 a[8:11], v1, s[32:35], s82 offen nt
    s_addk_i32 s82, 0x1000
    s_and_b32 s82, s82, s83
    s_waitcnt vmcnt(9)
    v_mfma_f32_16x16x32_bf16 v[24:27], v[16:19], a[56:59], v[24:27]
    v_and_b32_dpp v20, v6, v2 row_newbcast:15 row_mask:0xf bank_mask:0xf
    v_and_b32_dpp v21, v6, v3 row_newbcast:15 row_mask:0xf bank_mask:0xf
    v_and_b32_dpp v22, v6, v4 row_newbcast:15 row_mask:0xf bank_mask:0xf
    v_and_b32_dpp v23, v6, v5 row_newbcast:15 row_mask:0xf bank_mask:0xf
    s_mov_b32 s78, 69632
    buffer_load_dwordx4 a[152:155], v40, s[40:43], s78 offen offset:2048 nt
    s_waitcnt vmcnt(9)
    buffer_load_dwordx4 a[12:15], v1, s[32:35], s82 offen nt
    s_addk_i32 s82, 0x1000
    s_and_b32 s82, s82, s83
    s_waitcnt vmcnt(9)
    v_mfma_f32_16x16x32_bf16 v[24:27], v[20:23], a[60:63], v[24:27]
    v_and_b32_dpp v16, v7, v2 row_newbcast:0 row_mask:0xf bank_mask:0xf
    v_and_b32_dpp v17, v7, v3 row_newbcast:0 row_mask:0xf bank_mask:0xf
    v_and_b32_dpp v18, v7, v4 row_newbcast:0 row_mask:0xf bank_mask:0xf
    v_and_b32_dpp v19, v7, v5 row_newbcast:0 row_mask:0xf bank_mask:0xf
    buffer_load_ushort v39, v43, s[52:55], 0 offen
    s_waitcnt vmcnt(9)
    buffer_load_dwordx4 a[16:19], v1, s[32:35], s82 offen nt
    s_addk_i32 s82, 0x1000
    s_and_b32 s82, s82, s83
    s_waitcnt vmcnt(9)
    buffer_load_dwordx4 a[20:23], v1, s[32:35], s82 offen nt
    s_addk_i32 s82, 0x1000
    s_and_b32 s82, s82, s83
    s_waitcnt vmcnt(9)
    v_mfma_f32_16x16x32_bf16 v[24:27], v[16:19], a[0:3], v[24:27]
    v_and_b32_dpp v20, v7, v2 row_newbcast:8 row_mask:0xf bank_mask:0xf
    v_and_b32_dpp v21, v7, v3 row_newbcast:8 row_mask:0xf bank_mask:0xf
    v_and_b32_dpp v22, v7, v4 row_newbcast:8 row_mask:0xf bank_mask:0xf
    v_and_b32_dpp v23, v7, v5 row_newbcast:8 row_mask:0xf bank_mask:0xf
    v_accvgpr_read_b32 v64, a104
    v_accvgpr_read_b32 v65, a105
    v_accvgpr_read_b32 v66, a106
    v_accvgpr_read_b32 v67, a107
    v_accvgpr_read_b32 v68, a108
    v_accvgpr_read_b32 v69, a109
    v_accvgpr_read_b32 v70, a110
    v_accvgpr_read_b32 v71, a111
    v_perm_b32 v133, v68, v64, s88
    v_perm_b32 v149, v68, v64, s89
    v_perm_b32 v165, v69, v65, s88
    v_perm_b32 v181, v69, v65, s89
    v_perm_b32 v197, v70, v66, s88
    v_perm_b32 v213, v70, v66, s89
    v_perm_b32 v229, v71, v67, s88
    v_perm_b32 v245, v71, v67, s89
    s_mov_b32 s78, 69632
    buffer_load_dwordx4 a[156:159], v40, s[40:43], s78 offen offset:3072 nt
    s_waitcnt vmcnt(9)
    buffer_load_dwordx4 a[24:27], v1, s[32:35], s82 offen nt
    s_addk_i32 s82, 0x1000
    s_and_b32 s82, s82, s83
    s_waitcnt vmcnt(9)
    v_mfma_f32_16x16x32_bf16 v[24:27], v[20:23], a[4:7], v[24:27]
    v_and_b32_dpp v16, v7, v2 row_newbcast:4 row_mask:0xf bank_mask:0xf
    v_and_b32_dpp v17, v7, v3 row_newbcast:4 row_mask:0xf bank_mask:0xf
    v_and_b32_dpp v18, v7, v4 row_newbcast:4 row_mask:0xf bank_mask:0xf
    v_and_b32_dpp v19, v7, v5 row_newbcast:4 row_mask:0xf bank_mask:0xf
    buffer_load_dwordx4 a[28:31], v1, s[32:35], s82 offen nt
    s_addk_i32 s82, 0x1000
    s_and_b32 s82, s82, s83
    s_waitcnt vmcnt(9)
    v_accvgpr_read_b32 v72, a236
    v_accvgpr_read_b32 v73, a237
    v_accvgpr_read_b32 v74, a238
    v_accvgpr_read_b32 v75, a239
    v_accvgpr_read_b32 v76, a240
    v_accvgpr_read_b32 v77, a241
    v_accvgpr_read_b32 v78, a242
    v_accvgpr_read_b32 v79, a243
    v_cmp_gt_u32 vcc, s58, v42
    v_and_b32 v32, s91, v0
    v_and_b32 v33, s91, v38
    v_cndmask_b32 v32, 0, v32, vcc
    v_cndmask_b32 v33, 0, v33, vcc
    v_xor_b32 v72, v32, v72
    v_xor_b32 v73, v32, v73
    v_xor_b32 v74, v32, v74
    v_xor_b32 v75, v33, v75
    v_xor_b32 v76, v32, v76
    v_xor_b32 v77, v32, v77
    v_xor_b32 v78, v32, v78
    v_xor_b32 v79, v33, v79
    v_or3_b32 v30, v72, v73, v74
    v_or3_b32 v30, v30, v75, v76
    v_or3_b32 v30, v30, v77, v78
    v_or_b32 v30, v30, v79
    v_and_b32 v30, s91, v30
    v_cmp_ne_u32 vcc, 0, v30
    s_cbranch_vccnz L_slow_fu
L_ok_fu:
    v_pk_add_f32 v[72:73], v[72:73], v[76:77]
    v_pk_add_f32 v[74:75], v[74:75], v[78:79]
    v_perm_b32 v48, v84, v80, s88
    v_perm_b32 v50, v84, v80, s89
    v_perm_b32 v52, v85, v81, s88
    v_perm_b32 v54, v85, v81, s89
    v_perm_b32 v56, v86, v82, s88
    v_perm_b32 v58, v86, v82, s89
    v_perm_b32 v60, v87, v83, s88
    v_perm_b32 v62, v87, v83, s89
    v_perm_b32 v49, v92, v88, s88
    v_perm_b32 v51, v92, v88, s89
    v_perm_b32 v53, v93, v89, s88
    v_perm_b32 v55, v93, v89, s89
    v_perm_b32 v57, v94, v90, s88
    v_perm_b32 v59, v94, v90, s89
    v_perm_b32 v61, v95, v91, s88
    v_perm_b32 v63, v95, v91, s89
    v_add_f32_dpp v72, v72, v72 row_ror:8 row_mask:0xf bank_mask:0xf
    v_add_f32_dpp v73, v73, v73 row_ror:8 row_mask:0xf bank_mask:0xf
    v_add_f32_dpp v74, v74, v74 row_ror:8 row_mask:0xf bank_mask:0xf
    v_add_f32_dpp v75, v75, v75 row_ror:8 row_mask:0xf bank_mask:0xf
    s_nop 0
    v_permlane32_swap_b32 v72, v74
    v_permlane32_swap_b32 v73, v75
    v_add_f32 v72, v72, v74
    v_add_f32 v73, v73, v75
    v_mov_b32 v30, v72
    s_nop 1
    v_permlane16_swap_b32 v72, v30
    v_add_f32 v72, v72, v30
    v_mov_b32 v31, v73
    s_nop 1
    v_permlane16_swap_b32 v73, v31
    v_add_f32 v73, v73, v31
    v_cvt_pk_bf16_f32 v72, v72, v72
    v_and_b32 v72, 0xffff0000, v72
    v_cvt_pk_bf16_f32 v73, v73, v73
    v_and_b32 v73, 0xffff0000, v73
    v_mul_f32 v30, 3216550459, v72
    v_exp_f32 v30, v30
    v_and_b32 v32, 7, v15
    v_add_f32 v30, 1.0, v30
    v_rcp_f32 v30, v30
    v_cmp_eq_u32 vcc, 0, v32
    v_mul_f32 v72, v72, v30
    s_nop 0
    v_cndmask_b32 v32, 0, -1, vcc
    v_cvt_pk_bf16_f32 v72, v72, v72
    v_and_b32 v72, 0xffff0000, v72
    v_mul_f32 v72, v72, v73
    v_mov_b32 v76, 0
    v_mov_b32 v30, v72
    v_mov_b32 v77, 0
    s_nop 0
    v_permlane32_swap_b32 v72, v30
    v_cvt_pk_bf16_f32 v72, v72, v30
    s_nop 1
    v_and_b32_dpp v76, v72, v32 row_newbcast:0 row_mask:0x1 bank_mask:0xf
    v_and_b32_dpp v77, v72, v32 row_newbcast:1 row_mask:0x1 bank_mask:0xf
    s_nop 0
    v_and_b32_dpp v76, v72, v32 row_newbcast:2 row_mask:0x2 bank_mask:0xf
    v_and_b32_dpp v77, v72, v32 row_newbcast:3 row_mask:0x2 bank_mask:0xf
    s_nop 0
    v_and_b32_dpp v76, v72, v32 row_newbcast:4 row_mask:0x4 bank_mask:0xf
    v_and_b32_dpp v77, v72, v32 row_newbcast:5 row_mask:0x4 bank_mask:0xf
    s_nop 1
    v_mfma_f32_16x16x16_bf16 v[96:99], v[76:77], v[48:49], 0
    v_mfma_f32_16x16x16_bf16 v[100:103], v[76:77], v[50:51], 0
    v_mfma_f32_16x16x16_bf16 v[104:107], v[76:77], v[52:53], 0
    v_mfma_f32_16x16x16_bf16 v[108:111], v[76:77], v[54:55], 0
    v_mfma_f32_16x16x16_bf16 v[112:115], v[76:77], v[56:57], 0
    v_mfma_f32_16x16x16_bf16 v[116:119], v[76:77], v[58:59], 0
    v_mfma_f32_16x16x16_bf16 v[120:123], v[76:77], v[60:61], 0
    v_mfma_f32_16x16x16_bf16 v[124:127], v[76:77], v[62:63], 0
    buffer_load_dwordx4 a[32:35], v1, s[32:35], s82 offen nt
    s_addk_i32 s82, 0x1000
    s_and_b32 s82, s82, s83
    s_waitcnt vmcnt(9)
    v_mfma_f32_16x16x32_bf16 v[24:27], v[16:19], a[8:11], v[24:27]
    v_and_b32_dpp v20, v7, v2 row_newbcast:12 row_mask:0xf bank_mask:0xf
    v_and_b32_dpp v21, v7, v3 row_newbcast:12 row_mask:0xf bank_mask:0xf
    v_and_b32_dpp v22, v7, v4 row_newbcast:12 row_mask:0xf bank_mask:0xf
    v_and_b32_dpp v23, v7, v5 row_newbcast:12 row_mask:0xf bank_mask:0xf
    s_mov_b32 s78, 98304
    buffer_load_dwordx4 a[160:163], v40, s[40:43], s78 offen offset:0 nt
    s_waitcnt vmcnt(9)
    buffer_load_dwordx4 a[36:39], v1, s[32:35], s82 offen nt
    s_addk_i32 s82, 0x1000
    s_and_b32 s82, s82, s83
    s_waitcnt vmcnt(9)
    v_mfma_f32_16x16x32_bf16 v[24:27], v[20:23], a[12:15], v[24:27]
    v_and_b32_dpp v16, v7, v2 row_newbcast:2 row_mask:0xf bank_mask:0xf
    v_and_b32_dpp v17, v7, v3 row_newbcast:2 row_mask:0xf bank_mask:0xf
    v_and_b32_dpp v18, v7, v4 row_newbcast:2 row_mask:0xf bank_mask:0xf
    v_and_b32_dpp v19, v7, v5 row_newbcast:2 row_mask:0xf bank_mask:0xf
    v_accvgpr_read_b32 v64, a112
    v_accvgpr_read_b32 v65, a113
    v_accvgpr_read_b32 v66, a114
    v_accvgpr_read_b32 v67, a115
    v_accvgpr_read_b32 v68, a116
    v_accvgpr_read_b32 v69, a117
    v_accvgpr_read_b32 v70, a118
    v_accvgpr_read_b32 v71, a119
    v_perm_b32 v134, v68, v64, s88
    v_perm_b32 v150, v68, v64, s89
    v_perm_b32 v166, v69, v65, s88
    v_perm_b32 v182, v69, v65, s89
    v_perm_b32 v198, v70, v66, s88
    v_perm_b32 v214, v70, v66, s89
    v_perm_b32 v230, v71, v67, s88
    v_perm_b32 v246, v71, v67, s89
    buffer_load_dwordx4 a[40:43], v1, s[32:35], s82 offen nt
    s_addk_i32 s82, 0x1000
    s_and_b32 s82, s82, s83
    s_waitcnt vmcnt(9)
    s_mov_b32 s78, 98304
    buffer_load_dwordx4 a[164:167], v40, s[40:43], s78 offen offset:1024 nt
    s_waitcnt vmcnt(9)
    v_mfma_f32_16x16x32_bf16 v[24:27], v[16:19], a[16:19], v[24:27]
    v_and_b32_dpp v20, v7, v2 row_newbcast:10 row_mask:0xf bank_mask:0xf
    v_and_b32_dpp v21, v7, v3 row_newbcast:10 row_mask:0xf bank_mask:0xf
    v_and_b32_dpp v22, v7, v4 row_newbcast:10 row_mask:0xf bank_mask:0xf
    v_and_b32_dpp v23, v7, v5 row_newbcast:10 row_mask:0xf bank_mask:0xf
    buffer_load_dwordx4 a[44:47], v1, s[32:35], s82 offen nt
    s_addk_i32 s82, 0x1000
    s_and_b32 s82, s82, s83
    s_waitcnt vmcnt(9)
    v_mfma_f32_16x16x32_bf16 v[24:27], v[20:23], a[20:23], v[24:27]
    v_and_b32_dpp v16, v7, v2 row_newbcast:6 row_mask:0xf bank_mask:0xf
    v_and_b32_dpp v17, v7, v3 row_newbcast:6 row_mask:0xf bank_mask:0xf
    v_and_b32_dpp v18, v7, v4 row_newbcast:6 row_mask:0xf bank_mask:0xf
    v_and_b32_dpp v19, v7, v5 row_newbcast:6 row_mask:0xf bank_mask:0xf
    buffer_load_dwordx4 a[48:51], v1, s[32:35], s82 offen nt
    s_addk_i32 s82, 0x1000
    s_and_b32 s82, s82, s83
    s_waitcnt vmcnt(9)
    buffer_load_dwordx4 a[52:55], v1, s[32:35], s82 offen nt
    s_addk_i32 s82, 0x1000
    s_and_b32 s82, s82, s83
    s_waitcnt vmcnt(9)
    v_mfma_f32_16x16x32_bf16 v[24:27], v[16:19], a[24:27], v[24:27]
    v_and_b32_dpp v20, v7, v2 row_newbcast:14 row_mask:0xf bank_mask:0xf
    v_and_b32_dpp v21, v7, v3 row_newbcast:14 row_mask:0xf bank_mask:0xf
    v_and_b32_dpp v22, v7, v4 row_newbcast:14 row_mask:0xf bank_mask:0xf
    v_and_b32_dpp v23, v7, v5 row_newbcast:14 row_mask:0xf bank_mask:0xf
    v_accvgpr_read_b32 v64, a120
    v_accvgpr_read_b32 v65, a121
    v_accvgpr_read_b32 v66, a122
    v_accvgpr_read_b32 v67, a123
    v_accvgpr_read_b32 v68, a124
    v_accvgpr_read_b32 v69, a125
    v_accvgpr_read_b32 v70, a126
    v_accvgpr_read_b32 v71, a127
    v_perm_b32 v135, v68, v64, s88
    v_perm_b32 v151, v68, v64, s89
    v_perm_b32 v167, v69, v65, s88
    v_perm_b32 v183, v69, v65, s89
    v_perm_b32 v199, v70, v66, s88
    v_perm_b32 v215, v70, v66, s89
    v_perm_b32 v231, v71, v67, s88
    v_perm_b32 v247, v71, v67, s89
    s_mov_b32 s78, 98304
    buffer_load_dwordx4 a[168:171], v40, s[40:43], s78 offen offset:2048 nt
    s_waitcnt vmcnt(9)
    v_mfma_f32_16x16x32_bf16 v[24:27], v[20:23], a[28:31], v[24:27]
    v_and_b32_dpp v16, v7, v2 row_newbcast:1 row_mask:0xf bank_mask:0xf
    v_and_b32_dpp v17, v7, v3 row_newbcast:1 row_mask:0xf bank_mask:0xf
    v_and_b32_dpp v18, v7, v4 row_newbcast:1 row_mask:0xf bank_mask:0xf
    v_and_b32_dpp v19, v7, v5 row_newbcast:1 row_mask:0xf bank_mask:0xf
    buffer_load_dwordx4 a[56:59], v1, s[32:35], s82 offen nt
    s_addk_i32 s82, 0x1000
    s_and_b32 s82, s82, s83
    s_waitcnt vmcnt(9)
    v_mfma_f32_16x16x32_bf16 v[24:27], v[16:19], a[32:35], v[24:27]
    v_and_b32_dpp v20, v7, v2 row_newbcast:9 row_mask:0xf bank_mask:0xf
    v_and_b32_dpp v21, v7, v3 row_newbcast:9 row_mask:0xf bank_mask:0xf
    v_and_b32_dpp v22, v7, v4 row_newbcast:9 row_mask:0xf bank_mask:0xf
    v_and_b32_dpp v23, v7, v5 row_newbcast:9 row_mask:0xf bank_mask:0xf
    buffer_load_dwordx4 a[60:63], v1, s[32:35], s82 offen nt
    s_addk_i32 s82, 0x1000
    s_and_b32 s82, s82, s83
    s_waitcnt vmcnt(9)
    buffer_load_dwordx4 a[0:3], v1, s[32:35], s82 offen nt
    s_addk_i32 s82, 0x1000
    s_and_b32 s82, s82, s83
    s_waitcnt vmcnt(9)
    v_mfma_f32_16x16x32_bf16 v[24:27], v[20:23], a[36:39], v[24:27]
    v_and_b32_dpp v16, v7, v2 row_newbcast:5 row_mask:0xf bank_mask:0xf
    v_and_b32_dpp v17, v7, v3 row_newbcast:5 row_mask:0xf bank_mask:0xf
    v_and_b32_dpp v18, v7, v4 row_newbcast:5 row_mask:0xf bank_mask:0xf
    v_and_b32_dpp v19, v7, v5 row_newbcast:5 row_mask:0xf bank_mask:0xf
    v_accvgpr_read_b32 v64, a128
    v_accvgpr_read_b32 v65, a129
    v_accvgpr_read_b32 v66, a130
    v_accvgpr_read_b32 v67, a131
    v_accvgpr_read_b32 v68, a132
    v_accvgpr_read_b32 v69, a133
    v_accvgpr_read_b32 v70, a134
    v_accvgpr_read_b32 v71, a135
    v_perm_b32 v136, v68, v64, s88
    v_perm_b32 v152, v68, v64, s89
    v_perm_b32 v168, v69, v65, s88
    v_perm_b32 v184, v69, v65, s89
    v_perm_b32 v200, v70, v66, s88
    v_perm_b32 v216, v70, v66, s89
    v_perm_b32 v232, v71, v67, s88
    v_perm_b32 v248, v71, v67, s89
    s_mov_b32 s78, 98304
    buffer_load_dwordx4 a[172:175], v40, s[40:43], s78 offen offset:3072 nt
    s_waitcnt vmcnt(9)
    v_mfma_f32_16x16x32_bf16 v[24:27], v[16:19], a[40:43], v[24:27]
    v_and_b32_dpp v20, v7, v2 row_newbcast:13 row_mask:0xf bank_mask:0xf
    v_and_b32_dpp v21, v7, v3 row_newbcast:13 row_mask:0xf bank_mask:0xf
    v_and_b32_dpp v22, v7, v4 row_newbcast:13 row_mask:0xf bank_mask:0xf
    v_and_b32_dpp v23, v7, v5 row_newbcast:13 row_mask:0xf bank_mask:0xf
    buffer_load_dwordx4 a[4:7], v1, s[32:35], s82 offen nt
    s_addk_i32 s82, 0x1000
    s_and_b32 s82, s82, s83
    s_waitcnt vmcnt(9)
    buffer_load_dwordx4 a[8:11], v1, s[32:35], s82 offen nt
    s_addk_i32 s82, 0x1000
    s_and_b32 s82, s82, s83
    s_waitcnt vmcnt(9)
    v_mfma_f32_16x16x32_bf16 v[24:27], v[20:23], a[44:47], v[24:27]
    v_and_b32_dpp v16, v7, v2 row_newbcast:3 row_mask:0xf bank_mask:0xf
    v_and_b32_dpp v17, v7, v3 row_newbcast:3 row_mask:0xf bank_mask:0xf
    v_and_b32_dpp v18, v7, v4 row_newbcast:3 row_mask:0xf bank_mask:0xf
    v_and_b32_dpp v19, v7, v5 row_newbcast:3 row_mask:0xf bank_mask:0xf
    buffer_load_dwordx4 a[12:15], v1, s[32:35], s82 offen nt
    s_addk_i32 s82, 0x1000
    s_and_b32 s82, s82, s83
    s_waitcnt vmcnt(9)
    v_mfma_f32_16x16x32_bf16 v[24:27], v[16:19], a[48:51], v[24:27]
    v_and_b32_dpp v20, v7, v2 row_newbcast:11 row_mask:0xf bank_mask:0xf
    v_and_b32_dpp v21, v7, v3 row_newbcast:11 row_mask:0xf bank_mask:0xf
    v_and_b32_dpp v22, v7, v4 row_newbcast:11 row_mask:0xf bank_mask:0xf
    v_and_b32_dpp v23, v7, v5 row_newbcast:11 row_mask:0xf bank_mask:0xf
    v_accvgpr_read_b32 v64, a136
    v_accvgpr_read_b32 v65, a137
    v_accvgpr_read_b32 v66, a138
    v_accvgpr_read_b32 v67, a139
    v_accvgpr_read_b32 v68, a140
    v_accvgpr_read_b32 v69, a141
    v_accvgpr_read_b32 v70, a142
    v_accvgpr_read_b32 v71, a143
    v_perm_b32 v137, v68, v64, s88
    v_perm_b32 v153, v68, v64, s89
    v_perm_b32 v169, v69, v65, s88
    v_perm_b32 v185, v69, v65, s89
    v_perm_b32 v201, v70, v66, s88
    v_perm_b32 v217, v70, v66, s89
    v_perm_b32 v233, v71, v67, s88
    v_perm_b32 v249, v71, v67, s89
    s_mov_b32 s78, 102400
    buffer_load_dwordx4 a[176:179], v40, s[40:43], s78 offen offset:0 nt
    s_waitcnt vmcnt(9)
    v_mfma_f32_16x16x32_bf16 v[24:27], v[20:23], a[52:55], v[24:27]
    v_and_b32_dpp v16, v7, v2 row_newbcast:7 row_mask:0xf bank_mask:0xf
    v_and_b32_dpp v17, v7, v3 row_newbcast:7 row_mask:0xf bank_mask:0xf
    v_and_b32_dpp v18, v7, v4 row_newbcast:7 row_mask:0xf bank_mask:0xf
    v_and_b32_dpp v19, v7, v5 row_newbcast:7 row_mask:0xf bank_mask:0xf
    buffer_load_dwordx4 a[16:19], v1, s[32:35], s82 offen nt
    s_addk_i32 s82, 0x1000
    s_and_b32 s82, s82, s83
    s_waitcnt vmcnt(9)
    buffer_load_dwordx4 a[20:23], v1, s[32:35], s82 offen nt
    s_addk_i32 s82, 0x1000
    s_and_b32 s82, s82, s83
    s_waitcnt vmcnt(9)
    v_mfma_f32_16x16x32_bf16 v[24:27], v[16:19], a[56:59], v[24:27]
    v_and_b32_dpp v20, v7, v2 row_newbcast:15 row_mask:0xf bank_mask:0xf
    v_and_b32_dpp v21, v7, v3 row_newbcast:15 row_mask:0xf bank_mask:0xf
    v_and_b32_dpp v22, v7, v4 row_newbcast:15 row_mask:0xf bank_mask:0xf
    v_and_b32_dpp v23, v7, v5 row_newbcast:15 row_mask:0xf bank_mask:0xf
    s_mov_b32 s78, 102400
    buffer_load_dwordx4 a[180:183], v40, s[40:43], s78 offen offset:1024 nt
    s_waitcnt vmcnt(9)
    v_mfma_f32_16x16x32_bf16 v[24:27], v[20:23], a[60:63], v[24:27]
    v_and_b32_dpp v16, v8, v2 row_newbcast:0 row_mask:0xf bank_mask:0xf
    v_and_b32_dpp v17, v8, v3 row_newbcast:0 row_mask:0xf bank_mask:0xf
    v_and_b32_dpp v18, v8, v4 row_newbcast:0 row_mask:0xf bank_mask:0xf
    v_and_b32_dpp v19, v8, v5 row_newbcast:0 row_mask:0xf bank_mask:0xf
    v_accvgpr_read_b32 v64, a144
    v_accvgpr_read_b32 v65, a145
    v_accvgpr_read_b32 v66, a146
    v_accvgpr_read_b32 v67, a147
    v_accvgpr_read_b32 v68, a148
    v_accvgpr_read_b32 v69, a149
    v_accvgpr_read_b32 v70, a150
    v_accvgpr_read_b32 v71, a151
    v_perm_b32 v138, v68, v64, s88
    v_perm_b32 v154, v68, v64, s89
    v_perm_b32 v170, v69, v65, s88
    v_perm_b32 v186, v69, v65, s89
    v_perm_b32 v202, v70, v66, s88
    v_perm_b32 v218, v70, v66, s89
    v_perm_b32 v234, v71, v67, s88
    v_perm_b32 v250, v71, v67, s89
    buffer_load_dwordx4 a[24:27], v1, s[32:35], s82 offen nt
    s_addk_i32 s82, 0x1000
    s_and_b32 s82, s82, s83
    s_waitcnt vmcnt(9)
    v_mfma_f32_16x16x32_bf16 v[24:27], v[16:19], a[0:3], v[24:27]
    v_and_b32_dpp v20, v8, v2 row_newbcast:8 row_mask:0xf bank_mask:0xf
    v_and_b32_dpp v21, v8, v3 row_newbcast:8 row_mask:0xf bank_mask:0xf
    v_and_b32_dpp v22, v8, v4 row_newbcast:8 row_mask:0xf bank_mask:0xf
    v_and_b32_dpp v23, v8, v5 row_newbcast:8 row_mask:0xf bank_mask:0xf
    buffer_load_dwordx4 a[28:31], v1, s[32:35], s82 offen nt
    s_addk_i32 s82, 0x1000
    s_and_b32 s82, s82, s83
    s_waitcnt vmcnt(9)
    buffer_load_dwordx4 a[32:35], v1, s[32:35], s82 offen nt
    s_addk_i32 s82, 0x1000
    s_and_b32 s82, s82, s83
    s_waitcnt vmcnt(9)
    v_mfma_f32_16x16x32_bf16 v[24:27], v[20:23], a[4:7], v[24:27]
    v_and_b32_dpp v16, v8, v2 row_newbcast:4 row_mask:0xf bank_mask:0xf
    v_and_b32_dpp v17, v8, v3 row_newbcast:4 row_mask:0xf bank_mask:0xf
    v_and_b32_dpp v18, v8, v4 row_newbcast:4 row_mask:0xf bank_mask:0xf
    v_and_b32_dpp v19, v8, v5 row_newbcast:4 row_mask:0xf bank_mask:0xf
    s_mov_b32 s78, 102400
    buffer_load_dwordx4 a[184:187], v40, s[40:43], s78 offen offset:2048 nt
    s_waitcnt vmcnt(9)
    v_mfma_f32_16x16x32_bf16 v[24:27], v[16:19], a[8:11], v[24:27]
    v_and_b32_dpp v20, v8, v2 row_newbcast:12 row_mask:0xf bank_mask:0xf
    v_and_b32_dpp v21, v8, v3 row_newbcast:12 row_mask:0xf bank_mask:0xf
    v_and_b32_dpp v22, v8, v4 row_newbcast:12 row_mask:0xf bank_mask:0xf
    v_and_b32_dpp v23, v8, v5 row_newbcast:12 row_mask:0xf bank_mask:0xf
    v_accvgpr_read_b32 v64, a152
    v_accvgpr_read_b32 v65, a153
    v_accvgpr_read_b32 v66, a154
    v_accvgpr_read_b32 v67, a155
    v_accvgpr_read_b32 v68, a156
    v_accvgpr_read_b32 v69, a157
    v_accvgpr_read_b32 v70, a158
    v_accvgpr_read_b32 v71, a159
    v_perm_b32 v139, v68, v64, s88
    v_perm_b32 v155, v68, v64, s89
    v_perm_b32 v171, v69, v65, s88
    v_perm_b32 v187, v69, v65, s89
    v_perm_b32 v203, v70, v66, s88
    v_perm_b32 v219, v70, v66, s89
    v_perm_b32 v235, v71, v67, s88
    v_perm_b32 v251, v71, v67, s89
    s_lshl_b32 s78, s75, 8
    s_add_u32 s78, s78, 786432
    v_lshl_add_u32 v36, v29, 4, s78
    buffer_load_dwordx4 v[10:13], v36, s[56:59], 0 offen
    s_waitcnt vmcnt(9)
    v_mfma_f32_16x16x32_bf16 v[24:27], v[20:23], a[12:15], v[24:27]
    v_and_b32_dpp v16, v8, v2 row_newbcast:2 row_mask:0xf bank_mask:0xf
    v_and_b32_dpp v17, v8, v3 row_newbcast:2 row_mask:0xf bank_mask:0xf
    v_and_b32_dpp v18, v8, v4 row_newbcast:2 row_mask:0xf bank_mask:0xf
    v_and_b32_dpp v19, v8, v5 row_newbcast:2 row_mask:0xf bank_mask:0xf
    buffer_load_dwordx4 a[36:39], v1, s[32:35], s82 offen nt
    s_addk_i32 s82, 0x1000
    s_and_b32 s82, s82, s83
    s_waitcnt vmcnt(9)
    buffer_load_dwordx4 a[40:43], v1, s[32:35], s82 offen nt
    s_addk_i32 s82, 0x1000
    s_and_b32 s82, s82, s83
    s_waitcnt vmcnt(9)
    v_mfma_f32_16x16x32_bf16 v[24:27], v[16:19], a[16:19], v[24:27]
    v_and_b32_dpp v20, v8, v2 row_newbcast:10 row_mask:0xf bank_mask:0xf
    v_and_b32_dpp v21, v8, v3 row_newbcast:10 row_mask:0xf bank_mask:0xf
    v_and_b32_dpp v22, v8, v4 row_newbcast:10 row_mask:0xf bank_mask:0xf
    v_and_b32_dpp v23, v8, v5 row_newbcast:10 row_mask:0xf bank_mask:0xf
    buffer_load_dwordx4 a[44:47], v1, s[32:35], s82 offen nt
    s_addk_i32 s82, 0x1000
    s_and_b32 s82, s82, s83
    s_waitcnt vmcnt(9)
    v_mfma_f32_16x16x32_bf16 v[24:27], v[20:23], a[20:23], v[24:27]
    v_and_b32_dpp v16, v8, v2 row_newbcast:6 row_mask:0xf bank_mask:0xf
    v_and_b32_dpp v17, v8, v3 row_newbcast:6 row_mask:0xf bank_mask:0xf
    v_and_b32_dpp v18, v8, v4 row_newbcast:6 row_mask:0xf bank_mask:0xf
    v_and_b32_dpp v19, v8, v5 row_newbcast:6 row_mask:0xf bank_mask:0xf
    v_accvgpr_read_b32 v64, a160
    v_accvgpr_read_b32 v65, a161
    v_accvgpr_read_b32 v66, a162
    v_accvgpr_read_b32 v67, a163
    v_accvgpr_read_b32 v68, a164
    v_accvgpr_read_b32 v69, a165
    v_accvgpr_read_b32 v70, a166
    v_accvgpr_read_b32 v71, a167
    v_perm_b32 v140, v68, v64, s88
    v_perm_b32 v156, v68, v64, s89
    v_perm_b32 v172, v69, v65, s88
    v_perm_b32 v188, v69, v65, s89
    v_perm_b32 v204, v70, v66, s88
    v_perm_b32 v220, v70, v66, s89
    v_perm_b32 v236, v71, v67, s88
    v_perm_b32 v252, v71, v67, s89
    s_mov_b32 s78, 102400
    buffer_load_dwordx4 a[188:191], v40, s[40:43], s78 offen offset:3072 nt
    s_waitcnt vmcnt(9)
    buffer_load_dwordx4 a[48:51], v1, s[32:35], s82 offen nt
    s_addk_i32 s82, 0x1000
    s_and_b32 s82, s82, s83
    s_waitcnt vmcnt(9)
    v_mfma_f32_16x16x32_bf16 v[24:27], v[16:19], a[24:27], v[24:27]
    v_and_b32_dpp v20, v8, v2 row_newbcast:14 row_mask:0xf bank_mask:0xf
    v_and_b32_dpp v21, v8, v3 row_newbcast:14 row_mask:0xf bank_mask:0xf
    v_and_b32_dpp v22, v8, v4 row_newbcast:14 row_mask:0xf bank_mask:0xf
    v_and_b32_dpp v23, v8, v5 row_newbcast:14 row_mask:0xf bank_mask:0xf
    buffer_load_dwordx4 a[52:55], v1, s[32:35], s82 offen nt
    s_addk_i32 s82, 0x1000
    s_and_b32 s82, s82, s83
    s_waitcnt vmcnt(9)
    v_mfma_f32_16x16x32_bf16 v[24:27], v[20:23], a[28:31], v[24:27]
    v_and_b32_dpp v16, v8, v2 row_newbcast:1 row_mask:0xf bank_mask:0xf
    v_and_b32_dpp v17, v8, v3 row_newbcast:1 row_mask:0xf bank_mask:0xf
    v_and_b32_dpp v18, v8, v4 row_newbcast:1 row_mask:0xf bank_mask:0xf
    v_and_b32_dpp v19, v8, v5 row_newbcast:1 row_mask:0xf bank_mask:0xf
    buffer_load_dwordx4 a[56:59], v1, s[32:35], s82 offen nt
    s_addk_i32 s82, 0x1000
    s_and_b32 s82, s82, s83
    s_waitcnt vmcnt(9)
    v_mfma_f32_16x16x32_bf16 v[24:27], v[16:19], a[32:35], v[24:27]
    v_and_b32_dpp v20, v8, v2 row_newbcast:9 row_mask:0xf bank_mask:0xf
    v_and_b32_dpp v21, v8, v3 row_newbcast:9 row_mask:0xf bank_mask:0xf
    v_and_b32_dpp v22, v8, v4 row_newbcast:9 row_mask:0xf bank_mask:0xf
    v_and_b32_dpp v23, v8, v5 row_newbcast:9 row_mask:0xf bank_mask:0xf
    v_accvgpr_read_b32 v64, a168
    v_accvgpr_read_b32 v65, a169
    v_accvgpr_read_b32 v66, a170
    v_accvgpr_read_b32 v67, a171
    v_accvgpr_read_b32 v68, a172
    v_accvgpr_read_b32 v69, a173
    v_accvgpr_read_b32 v70, a174
    v_accvgpr_read_b32 v71, a175
    v_perm_b32 v141, v68, v64, s88
    v_perm_b32 v157, v68, v64, s89
    v_perm_b32 v173, v69, v65, s88
    v_perm_b32 v189, v69, v65, s89
    v_perm_b32 v205, v70, v66, s88
    v_perm_b32 v221, v70, v66, s89
    v_perm_b32 v237, v71, v67, s88
    v_perm_b32 v253, v71, v67, s89
    buffer_load_dwordx4 a[60:63], v1, s[32:35], s82 offen nt
    s_addk_i32 s82, 0x1000
    s_and_b32 s82, s82, s83
    s_waitcnt vmcnt(9)
    buffer_load_dwordx4 a[0:3], v1, s[32:35], s82 offen nt
    s_addk_i32 s82, 0x1000
    s_and_b32 s82, s82, s83
    s_waitcnt vmcnt(9)
    v_xor_b32 v10, v0, v10
    v_xor_b32 v11, v0, v11
    v_xor_b32 v12, s0, v12
    v_xor_b32 v13, s86, v13
    v_or_b32 v30, v10, v11
    v_and_b32 v30, s92, v30
    v_or_b32 v30, v30, v12
    v_or_b32 v30, v30, v13
    v_cmp_ne_u32 vcc, 0, v30
    s_cbranch_vccnz L_slow_ml
L_ok_ml:
    v_mov_b32 v12, v10
    s_nop 1
    v_max_f32_dpp v12, v12, v12 row_ror:8 row_mask:0xf bank_mask:0xf
    s_nop 1
    v_max_f32_dpp v12, v12, v12 row_ror:4 row_mask:0xf bank_mask:0xf
    s_nop 1
    v_max_f32_dpp v12, v12, v12 row_ror:2 row_mask:0xf bank_mask:0xf
    s_nop 1
    v_max_f32_dpp v12, v12, v12 row_ror:1 row_mask:0xf bank_mask:0xf
    v_sub_f32 v10, v10, v12
    v_sub_f32 v47, v34, v12
    v_mul_f32 v10, 1069066811, v10
    v_mul_f32 v47, 1069066811, v47
    v_exp_f32 v10, v10
    v_exp_f32 v47, v47
    v_mul_f32 v11, v11, v10
    s_nop 1
    v_add_f32_dpp v11, v11, v11 row_ror:8 row_mask:0xf bank_mask:0xf
    s_nop 1
    v_add_f32_dpp v11, v11, v11 row_ror:4 row_mask:0xf bank_mask:0xf
    s_nop 1
    v_add_f32_dpp v11, v11, v11 row_ror:2 row_mask:0xf bank_mask:0xf
    s_nop 1
    v_add_f32_dpp v11, v11, v11 row_ror:1 row_mask:0xf bank_mask:0xf
    v_rcp_f32 v11, v11
    s_nop 0
    v_mul_f32 v47, v47, v11
    v_bfe_u32 v30, v15, 2, 1
    v_mul_u32_u24 v30, 0xaaaa, v30
    v_add_u32 v42, 0x4444, v30
    buffer_load_dwordx4 a[4:7], v1, s[32:35], s82 offen nt
    s_addk_i32 s82, 0x1000
    s_and_b32 s82, s82, s83
    s_waitcnt vmcnt(9)
    v_mfma_f32_16x16x32_bf16 v[24:27], v[20:23], a[36:39], v[24:27]
    v_and_b32_dpp v16, v8, v2 row_newbcast:5 row_mask:0xf bank_mask:0xf
    v_and_b32_dpp v17, v8, v3 row_newbcast:5 row_mask:0xf bank_mask:0xf
    v_and_b32_dpp v18, v8, v4 row_newbcast:5 row_mask:0xf bank_mask:0xf
    v_and_b32_dpp v19, v8, v5 row_newbcast:5 row_mask:0xf bank_mask:0xf
    buffer_load_dwordx4 a[8:11], v1, s[32:35], s82 offen nt
    s_addk_i32 s82, 0x1000
    s_and_b32 s82, s82, s83
    s_waitcnt vmcnt(9)
    v_mfma_f32_16x16x32_bf16 v[24:27], v[16:19], a[40:43], v[24:27]
    v_and_b32_dpp v20, v8, v2 row_newbcast:13 row_mask:0xf bank_mask:0xf
    v_and_b32_dpp v21, v8, v3 row_newbcast:13 row_mask:0xf bank_mask:0xf
    v_and_b32_dpp v22, v8, v4 row_newbcast:13 row_mask:0xf bank_mask:0xf
    v_and_b32_dpp v23, v8, v5 row_newbcast:13 row_mask:0xf bank_mask:0xf
    buffer_load_dwordx4 a[12:15], v1, s[32:35], s82 offen nt
    s_addk_i32 s82, 0x1000
    s_and_b32 s82, s82, s83
    s_waitcnt vmcnt(9)
    v_mfma_f32_16x16x32_bf16 v[24:27], v[20:23], a[44:47], v[24:27]
    v_and_b32_dpp v16, v8, v2 row_newbcast:3 row_mask:0xf bank_mask:0xf
    v_and_b32_dpp v17, v8, v3 row_newbcast:3 row_mask:0xf bank_mask:0xf
    v_and_b32_dpp v18, v8, v4 row_newbcast:3 row_mask:0xf bank_mask:0xf
    v_and_b32_dpp v19, v8, v5 row_newbcast:3 row_mask:0xf bank_mask:0xf
    v_accvgpr_read_b32 v64, a176
    v_accvgpr_read_b32 v65, a177
    v_accvgpr_read_b32 v66, a178
    v_accvgpr_read_b32 v67, a179
    v_accvgpr_read_b32 v68, a180
    v_accvgpr_read_b32 v69, a181
    v_accvgpr_read_b32 v70, a182
    v_accvgpr_read_b32 v71, a183
    v_perm_b32 v142, v68, v64, s88
    v_perm_b32 v158, v68, v64, s89
    v_perm_b32 v174, v69, v65, s88
    v_perm_b32 v190, v69, v65, s89
    v_perm_b32 v206, v70, v66, s88
    v_perm_b32 v222, v70, v66, s89
    v_perm_b32 v238, v71, v67, s88
    v_perm_b32 v254, v71, v67, s89
    buffer_load_dwordx4 a[16:19], v1, s[32:35], s82 offen nt
    s_addk_i32 s82, 0x1000
    s_and_b32 s82, s82, s83
    s_waitcnt vmcnt(9)
    buffer_load_dwordx4 a[20:23], v1, s[32:35], s82 offen nt
    s_addk_i32 s82, 0x1000
    s_and_b32 s82, s82, s83
    s_waitcnt vmcnt(9)
    v_mfma_f32_16x16x32_bf16 v[24:27], v[16:19], a[48:51], v[24:27]
    v_and_b32_dpp v20, v8, v2 row_newbcast:11 row_mask:0xf bank_mask:0xf
    v_and_b32_dpp v21, v8, v3 row_newbcast:11 row_mask:0xf bank_mask:0xf
    v_and_b32_dpp v22, v8, v4 row_newbcast:11 row_mask:0xf bank_mask:0xf
    v_and_b32_dpp v23, v8, v5 row_newbcast:11 row_mask:0xf bank_mask:0xf
    buffer_load_dwordx4 a[24:27], v1, s[32:35], s82 offen nt
    s_addk_i32 s82, 0x1000
    s_and_b32 s82, s82, s83
    s_waitcnt vmcnt(9)
    v_mfma_f32_16x16x32_bf16 v[24:27], v[20:23], a[52:55], v[24:27]
    v_and_b32_dpp v16, v8, v2 row_newbcast:7 row_mask:0xf bank_mask:0xf
    v_and_b32_dpp v17, v8, v3 row_newbcast:7 row_mask:0xf bank_mask:0xf
    v_and_b32_dpp v18, v8, v4 row_newbcast:7 row_mask:0xf bank_mask:0xf
    v_and_b32_dpp v19, v8, v5 row_newbcast:7 row_mask:0xf bank_mask:0xf
    buffer_load_dwordx4 a[28:31], v1, s[32:35], s82 offen nt
    s_addk_i32 s82, 0x1000
    s_and_b32 s82, s82, s83
    s_waitcnt vmcnt(9)
    v_mfma_f32_16x16x32_bf16 v[24:27], v[16:19], a[56:59], v[24:27]
    v_and_b32_dpp v20, v8, v2 row_newbcast:15 row_mask:0xf bank_mask:0xf
    v_and_b32_dpp v21, v8, v3 row_newbcast:15 row_mask:0xf bank_mask:0xf
    v_and_b32_dpp v22, v8, v4 row_newbcast:15 row_mask:0xf bank_mask:0xf
    v_and_b32_dpp v23, v8, v5 row_newbcast:15 row_mask:0xf bank_mask:0xf
    v_accvgpr_read_b32 v64, a184
    v_accvgpr_read_b32 v65, a185
    v_accvgpr_read_b32 v66, a186
    v_accvgpr_read_b32 v67, a187
    v_accvgpr_read_b32 v68, a188
    v_accvgpr_read_b32 v69, a189
    v_accvgpr_read_b32 v70, a190
    v_accvgpr_read_b32 v71, a191
    v_perm_b32 v143, v68, v64, s88
    v_perm_b32 v159, v68, v64, s89
    v_perm_b32 v175, v69, v65, s88
    v_perm_b32 v191, v69, v65, s89
    v_perm_b32 v207, v70, v66, s88
    v_perm_b32 v223, v70, v66, s89
    v_perm_b32 v239, v71, v67, s88
    v_perm_b32 v255, v71, v67, s89
    buffer_load_dwordx4 a[32:35], v1, s[32:35], s82 offen nt
    s_addk_i32 s82, 0x1000
    s_and_b32 s82, s82, s83
    s_waitcnt vmcnt(9)
    v_mfma_f32_16x16x32_bf16 v[24:27], v[20:23], a[60:63], v[24:27]
    v_and_b32_dpp v16, v9, v2 row_newbcast:0 row_mask:0xf bank_mask:0xf
    v_and_b32_dpp v17, v9, v3 row_newbcast:0 row_mask:0xf bank_mask:0xf
    v_and_b32_dpp v18, v9, v4 row_newbcast:0 row_mask:0xf bank_mask:0xf
    v_and_b32_dpp v19, v9, v5 row_newbcast:0 row_mask:0xf bank_mask:0xf
    buffer_load_dwordx4 a[36:39], v1, s[32:35], s82 offen nt
    s_addk_i32 s82, 0x1000
    s_and_b32 s82, s82, s83
    s_waitcnt vmcnt(9)
    v_mfma_f32_16x16x32_bf16 v[24:27], v[16:19], a[0:3], v[24:27]
    v_and_b32_dpp v20, v9, v2 row_newbcast:8 row_mask:0xf bank_mask:0xf
    v_and_b32_dpp v21, v9, v3 row_newbcast:8 row_mask:0xf bank_mask:0xf
    v_and_b32_dpp v22, v9, v4 row_newbcast:8 row_mask:0xf bank_mask:0xf
    v_and_b32_dpp v23, v9, v5 row_newbcast:8 row_mask:0xf bank_mask:0xf
    buffer_load_dwordx4 a[40:43], v1, s[32:35], s82 offen nt
    s_addk_i32 s82, 0x1000
    s_and_b32 s82, s82, s83
    s_waitcnt vmcnt(9)
    v_mfma_f32_16x16x32_bf16 v[24:27], v[20:23], a[4:7], v[24:27]
    v_and_b32_dpp v16, v9, v2 row_newbcast:4 row_mask:0xf bank_mask:0xf
    v_and_b32_dpp v17, v9, v3 row_newbcast:4 row_mask:0xf bank_mask:0xf
    v_and_b32_dpp v18, v9, v4 row_newbcast:4 row_mask:0xf bank_mask:0xf
    v_and_b32_dpp v19, v9, v5 row_newbcast:4 row_mask:0xf bank_mask:0xf
    buffer_load_dwordx4 a[44:47], v1, s[32:35], s82 offen nt
    s_addk_i32 s82, 0x1000
    s_and_b32 s82, s82, s83
    s_waitcnt vmcnt(9)
    v_mfma_f32_16x16x32_bf16 v[24:27], v[16:19], a[8:11], v[24:27]
    v_and_b32_dpp v20, v9, v2 row_newbcast:12 row_mask:0xf bank_mask:0xf
    v_and_b32_dpp v21, v9, v3 row_newbcast:12 row_mask:0xf bank_mask:0xf
    v_and_b32_dpp v22, v9, v4 row_newbcast:12 row_mask:0xf bank_mask:0xf
    v_and_b32_dpp v23, v9, v5 row_newbcast:12 row_mask:0xf bank_mask:0xf
    buffer_load_dwordx4 a[48:51], v1, s[32:35], s82 offen nt
    s_addk_i32 s82, 0x1000
    s_and_b32 s82, s82, s83
    s_waitcnt vmcnt(9)
    v_mfma_f32_16x16x32_bf16 v[24:27], v[20:23], a[12:15], v[24:27]
    v_and_b32_dpp v16, v9, v2 row_newbcast:2 row_mask:0xf bank_mask:0xf
    v_and_b32_dpp v17, v9, v3 row_newbcast:2 row_mask:0xf bank_mask:0xf
    v_and_b32_dpp v18, v9, v4 row_newbcast:2 row_mask:0xf bank_mask:0xf
    v_and_b32_dpp v19, v9, v5 row_newbcast:2 row_mask:0xf bank_mask:0xf
    buffer_load_dwordx4 a[52:55], v1, s[32:35], s82 offen nt
    s_addk_i32 s82, 0x1000
    s_and_b32 s82, s82, s83
    s_waitcnt vmcnt(9)
    v_mfma_f32_16x16x32_bf16 v[24:27], v[16:19], a[16:19], v[24:27]
    v_and_b32_dpp v20, v9, v2 row_newbcast:10 row_mask:0xf bank_mask:0xf
    v_and_b32_dpp v21, v9, v3 row_newbcast:10 row_mask:0xf bank_mask:0xf
    v_and_b32_dpp v22, v9, v4 row_newbcast:10 row_mask:0xf bank_mask:0xf
    v_and_b32_dpp v23, v9, v5 row_newbcast:10 row_mask:0xf bank_mask:0xf
    buffer_load_dwordx4 a[56:59], v1, s[32:35], s82 offen nt
    s_addk_i32 s82, 0x1000
    s_and_b32 s82, s82, s83
    s_waitcnt vmcnt(9)
    v_mfma_f32_16x16x32_bf16 v[24:27], v[20:23], a[20:23], v[24:27]
    v_and_b32_dpp v16, v9, v2 row_newbcast:6 row_mask:0xf bank_mask:0xf
    v_and_b32_dpp v17, v9, v3 row_newbcast:6 row_mask:0xf bank_mask:0xf
    v_and_b32_dpp v18, v9, v4 row_newbcast:6 row_mask:0xf bank_mask:0xf
    v_and_b32_dpp v19, v9, v5 row_newbcast:6 row_mask:0xf bank_mask:0xf
    buffer_load_dwordx4 a[60:63], v1, s[32:35], s82 offen nt
    s_waitcnt vmcnt(9)
    v_mfma_f32_16x16x32_bf16 v[24:27], v[16:19], a[24:27], v[24:27]
    v_and_b32_dpp v20, v9, v2 row_newbcast:14 row_mask:0xf bank_mask:0xf
    v_and_b32_dpp v21, v9, v3 row_newbcast:14 row_mask:0xf bank_mask:0xf
    v_and_b32_dpp v22, v9, v4 row_newbcast:14 row_mask:0xf bank_mask:0xf
    v_and_b32_dpp v23, v9, v5 row_newbcast:14 row_mask:0xf bank_mask:0xf
    s_waitcnt vmcnt(8)
    s_nop 0
    v_mfma_f32_16x16x32_bf16 v[24:27], v[20:23], a[28:31], v[24:27]
    v_and_b32_dpp v16, v9, v2 row_newbcast:1 row_mask:0xf bank_mask:0xf
    v_and_b32_dpp v17, v9, v3 row_newbcast:1 row_mask:0xf bank_mask:0xf
    v_and_b32_dpp v18, v9, v4 row_newbcast:1 row_mask:0xf bank_mask:0xf
    v_and_b32_dpp v19, v9, v5 row_newbcast:1 row_mask:0xf bank_mask:0xf
    s_waitcnt vmcnt(7)
    s_nop 0
    v_mfma_f32_16x16x32_bf16 v[24:27], v[16:19], a[32:35], v[24:27]
    v_and_b32_dpp v20, v9, v2 row_newbcast:9 row_mask:0xf bank_mask:0xf
    v_and_b32_dpp v21, v9, v3 row_newbcast:9 row_mask:0xf bank_mask:0xf
    v_and_b32_dpp v22, v9, v4 row_newbcast:9 row_mask:0xf bank_mask:0xf
    v_and_b32_dpp v23, v9, v5 row_newbcast:9 row_mask:0xf bank_mask:0xf
    s_waitcnt vmcnt(6)
    s_nop 0
    v_mfma_f32_16x16x32_bf16 v[24:27], v[20:23], a[36:39], v[24:27]
    v_and_b32_dpp v16, v9, v2 row_newbcast:5 row_mask:0xf bank_mask:0xf
    v_and_b32_dpp v17, v9, v3 row_newbcast:5 row_mask:0xf bank_mask:0xf
    v_and_b32_dpp v18, v9, v4 row_newbcast:5 row_mask:0xf bank_mask:0xf
    v_and_b32_dpp v19, v9, v5 row_newbcast:5 row_mask:0xf bank_mask:0xf
    s_waitcnt vmcnt(5)
    s_nop 0
    v_mfma_f32_16x16x32_bf16 v[24:27], v[16:19], a[40:43], v[24:27]
    v_and_b32_dpp v20, v9, v2 row_newbcast:13 row_mask:0xf bank_mask:0xf
    v_and_b32_dpp v21, v9, v3 row_newbcast:13 row_mask:0xf bank_mask:0xf
    v_and_b32_dpp v22, v9, v4 row_newbcast:13 row_mask:0xf bank_mask:0xf
    v_and_b32_dpp v23, v9, v5 row_newbcast:13 row_mask:0xf bank_mask:0xf
    s_waitcnt vmcnt(4)
    s_nop 0
    v_mfma_f32_16x16x32_bf16 v[24:27], v[20:23], a[44:47], v[24:27]
    v_and_b32_dpp v16, v9, v2 row_newbcast:3 row_mask:0xf bank_mask:0xf
    v_and_b32_dpp v17, v9, v3 row_newbcast:3 row_mask:0xf bank_mask:0xf
    v_and_b32_dpp v18, v9, v4 row_newbcast:3 row_mask:0xf bank_mask:0xf
    v_and_b32_dpp v19, v9, v5 row_newbcast:3 row_mask:0xf bank_mask:0xf
    s_waitcnt vmcnt(3)
    s_nop 0
    v_mfma_f32_16x16x32_bf16 v[24:27], v[16:19], a[48:51], v[24:27]
    v_and_b32_dpp v20, v9, v2 row_newbcast:11 row_mask:0xf bank_mask:0xf
    v_and_b32_dpp v21, v9, v3 row_newbcast:11 row_mask:0xf bank_mask:0xf
    v_and_b32_dpp v22, v9, v4 row_newbcast:11 row_mask:0xf bank_mask:0xf
    v_and_b32_dpp v23, v9, v5 row_newbcast:11 row_mask:0xf bank_mask:0xf
    s_waitcnt vmcnt(2)
    s_nop 0
    v_mfma_f32_16x16x32_bf16 v[24:27], v[20:23], a[52:55], v[24:27]
    v_and_b32_dpp v16, v9, v2 row_newbcast:7 row_mask:0xf bank_mask:0xf
    v_and_b32_dpp v17, v9, v3 row_newbcast:7 row_mask:0xf bank_mask:0xf
    v_and_b32_dpp v18, v9, v4 row_newbcast:7 row_mask:0xf bank_mask:0xf
    v_and_b32_dpp v19, v9, v5 row_newbcast:7 row_mask:0xf bank_mask:0xf
    s_waitcnt vmcnt(1)
    s_nop 0
    v_mfma_f32_16x16x32_bf16 v[24:27], v[16:19], a[56:59], v[24:27]
    v_and_b32_dpp v20, v9, v2 row_newbcast:15 row_mask:0xf bank_mask:0xf
    v_and_b32_dpp v21, v9, v3 row_newbcast:15 row_mask:0xf bank_mask:0xf
    v_and_b32_dpp v22, v9, v4 row_newbcast:15 row_mask:0xf bank_mask:0xf
    v_and_b32_dpp v23, v9, v5 row_newbcast:15 row_mask:0xf bank_mask:0xf
    s_waitcnt vmcnt(0)
L_tail:
    s_nop 0
    v_mfma_f32_16x16x32_bf16 v[24:27], v[20:23], a[60:63], v[24:27]
    s_nop 7
    v_pk_mul_f32 v[24:25], v[24:25], v[46:47] op_sel:[0,1] op_sel_hi:[1,1]
    v_pk_mul_f32 v[26:27], v[26:27], v[46:47] op_sel:[0,1] op_sel_hi:[1,1]
    v_cvt_pk_bf16_f32 v24, v24, v25
    v_cvt_pk_bf16_f32 v25, v26, v27
    ds_write2_b32 v45, v24, v25 offset0:0 offset1:32
    s_waitcnt lgkmcnt(0)
    s_barrier
    ds_read_b128 v[64:67], v46 offset:8192
    ds_read_b128 v[68:71], v46 offset:8256
    s_waitcnt lgkmcnt(1)
    v_smfmac_f32_16x16x64_bf16 v[96:99], v[64:67], v[128:135], v42
    s_waitcnt lgkmcnt(0)
    v_smfmac_f32_16x16x64_bf16 v[96:99], v[68:71], v[136:143], v42
    v_smfmac_f32_16x16x64_bf16 v[112:115], v[64:67], v[192:199], v42
    v_smfmac_f32_16x16x64_bf16 v[112:115], v[68:71], v[200:207], v42
    v_smfmac_f32_16x16x64_bf16 v[100:103], v[64:67], v[144:151], v42
    v_smfmac_f32_16x16x64_bf16 v[100:103], v[68:71], v[152:159], v42
    v_smfmac_f32_16x16x64_bf16 v[116:119], v[64:67], v[208:215], v42
    s_nop 2
    v_pk_add_f32 v[96:97], v[96:97], v[98:99]
    v_add_f32 v96, v96, v97
    v_smfmac_f32_16x16x64_bf16 v[116:119], v[68:71], v[216:223], v42
    v_smfmac_f32_16x16x64_bf16 v[104:107], v[64:67], v[160:167], v42
    v_pk_add_f32 v[112:113], v[112:113], v[114:115]
    v_add_f32 v112, v112, v113
    v_smfmac_f32_16x16x64_bf16 v[104:107], v[68:71], v[168:175], v42
    s_nop 0
    v_permlane16_swap_b32 v96, v112
    v_add_f32 v16, v96, v112
    v_smfmac_f32_16x16x64_bf16 v[120:123], v[64:67], v[224:231], v42
    v_bfi_b32 v16, s92, v0, v16
    v_pk_add_f32 v[100:101], v[100:101], v[102:103]
    v_smfmac_f32_16x16x64_bf16 v[120:123], v[68:71], v[232:239], v42
    v_add_f32 v100, v100, v101
    v_smfmac_f32_16x16x64_bf16 v[108:111], v[64:67], v[176:183], v42
    v_pk_add_f32 v[116:117], v[116:117], v[118:119]
    v_add_f32 v116, v116, v117
    v_smfmac_f32_16x16x64_bf16 v[108:111], v[68:71], v[184:191], v42
    s_nop 0
    v_permlane16_swap_b32 v100, v116
    v_add_f32 v17, v100, v116
    v_smfmac_f32_16x16x64_bf16 v[124:127], v[64:67], v[240:247], v42
    v_bfi_b32 v17, s92, v0, v17
    v_pk_add_f32 v[104:105], v[104:105], v[106:107]
    v_smfmac_f32_16x16x64_bf16 v[124:127], v[68:71], v[248:255], v42
    v_add_f32 v104, v104, v105
    v_pk_add_f32 v[120:121], v[120:121], v[122:123]
    v_add_f32 v120, v120, v121
    s_nop 1
    v_permlane16_swap_b32 v104, v120
    v_add_f32 v18, v104, v120
    v_bfi_b32 v18, s92, v0, v18
    v_pk_add_f32 v[108:109], v[108:109], v[110:111]
    v_add_f32 v108, v108, v109
    v_pk_add_f32 v[124:125], v[124:125], v[126:127]
    v_add_f32 v124, v124, v125
    s_nop 1
    v_permlane16_swap_b32 v108, v124
    v_add_f32 v19, v108, v124
    v_bfi_b32 v19, s92, v0, v19
    s_mov_b32 exec_hi, 0
    buffer_store_dwordx4 v[16:19], v14, s[56:59], 0 offen sc1
    s_cmp_lg_u32 s1, 0
    s_cbranch_scc1 L_end
    s_mov_b32 s90, 400000
    s_mov_b32 exec_hi, -1
    s_lshl_b32 s79, s3, 8
    v_lshl_add_u32 v32, v15, 2, s79
    v_lshlrev_b32 v31, 2, v15
    v_lshlrev_b32 v39, 16, v39
    s_mov_b64 s[68:69], -1
    s_mov_b64 s[70:71], -1
L_poll:
    s_mov_b64 exec, s[68:69]
    buffer_load_dwordx4 v[64:67], v44, s[56:59], 0 offen offset:0 sc1
    s_mov_b64 exec, s[70:71]
    buffer_load_dwordx4 v[68:71], v44, s[56:59], 0 offen offset:2048 sc1
    s_sub_u32 s90, s90, 1
    s_cbranch_scc1 L_polled
    s_mov_b64 exec, s[68:69]
    s_waitcnt vmcnt(0)
    v_xor_b32 v64, v0, v64
    v_xor_b32 v65, v0, v65
    v_xor_b32 v66, v0, v66
    v_xor_b32 v67, v0, v67
    v_or3_b32 v30, v64, v65, v66
    v_or_b32 v30, v30, v67
    v_and_b32 v30, s92, v30
    v_cmp_ne_u32 s[68:69], 0, v30
    s_mov_b64 exec, s[70:71]
    v_xor_b32 v68, v0, v68
    v_xor_b32 v69, v0, v69
    v_xor_b32 v70, v0, v70
    v_xor_b32 v71, v0, v71
    v_or3_b32 v30, v68, v69, v70
    v_or_b32 v30, v30, v71
    v_and_b32 v30, s92, v30
    v_cmp_ne_u32 s[70:71], 0, v30
    s_or_b64 vcc, s[68:69], s[70:71]
    s_cbranch_scc0 L_polled
    s_bcnt1_i32_b64 s79, vcc
    s_cmp_le_u32 s79, 16
    s_cbranch_scc1 L_poll
    s_sleep 2
    s_branch L_poll
L_polled:
    s_mov_b64 exec, -1
    v_pk_add_f32 v[64:65], v[64:65], v[68:69]
    v_pk_add_f32 v[66:67], v[66:67], v[70:71]
    s_nop 0
    v_permlane32_swap_b32 v64, v65
    v_permlane32_swap_b32 v66, v67
    v_add_f32 v64, v64, v65
    v_add_f32 v66, v66, v67
    s_nop 1
    v_permlane16_swap_b32 v64, v66
    v_add_f32 v64, v64, v66
    s_nop 1
    v_add_f32_dpp v64, v64, v64 row_ror:8 row_mask:0xf bank_mask:0xf
    s_nop 1
    v_add_f32_dpp v64, v64, v64 row_ror:4 row_mask:0xf bank_mask:0xf
    ds_write_b32 v32, v64
    s_waitcnt lgkmcnt(0)
    s_barrier
    s_cmp_lg_u32 s3, 0
    s_cbranch_scc1 L_end
    ds_read2st64_b32 v[64:65], v31 offset0:0 offset1:1
    ds_read2st64_b32 v[66:67], v31 offset0:2 offset1:3
    s_waitcnt lgkmcnt(0)
    v_pk_add_f32 v[64:65], v[64:65], v[66:67]
    v_add_f32 v64, v64, v65
    v_add_f32 v64, v64, v39
    v_cvt_pk_bf16_f32 v64, v64, v64
    buffer_store_short v64, v43, s[60:63], 0 offen
    s_cmp_eq_u32 s2, 0
    s_cselect_b32 s78, 802816, 1073741824
    v_mov_b32 v30, s0
    v_mov_b32 v31, s78
    s_mov_b64 exec, 1
    buffer_store_dword v30, v31, s[56:59], 0 offen
L_end:
    s_endpgm
L_slow_q:
    v_accvgpr_read_b32 v30, a232
    buffer_store_dwordx4 a[224:227], v30, s[56:59], 0 offen sc1
    s_mov_b32 s90, 400000
L_miss_q:
    s_mov_b32 s79, 0
    s_sleep 1
L_retry_q:
    s_sub_u32 s90, s90, 1
    s_cbranch_scc1 L_ok_q
    buffer_load_dwordx4 v[232:235], v39, s[56:59], 0 offen offset:0 sc1
    buffer_load_dwordx4 v[236:239], v39, s[56:59], 0 offen offset:256 sc1
    s_movk_i32 s78, 0x1000
    buffer_load_dwordx4 v[240:243], v39, s[56:59], s78 offen offset:0 sc1
    buffer_load_dwordx4 v[244:247], v39, s[56:59], s78 offen offset:256 sc1
    s_waitcnt vmcnt(0)
    v_xor_b32 v232, v32, v232
    v_xor_b32 v233, v32, v233
    v_xor_b32 v236, v32, v236
    v_xor_b32 v237, v32, v237
    v_xor_b32 v240, v32, v240
    v_xor_b32 v241, v32, v241
    v_xor_b32 v244, v32, v244
    v_xor_b32 v245, v32, v245
    v_or3_b32 v30, v232, v233, v236
    v_or3_b32 v30, v30, v237, v240
    v_or3_b32 v30, v30, v241, v244
    v_or_b32 v30, v30, v245
    v_and_b32 v30, s93, v30
    v_cmp_ne_u32 vcc, 0, v30
    v_bfi_b32 v234, s93, 0, v234
    v_bfi_b32 v235, s93, 0, v235
    v_bfi_b32 v238, s93, 0, v238
    v_bfi_b32 v239, s93, 0, v239
    v_bfi_b32 v242, s93, 0, v242
    v_bfi_b32 v243, s93, 0, v243
    v_bfi_b32 v246, s93, 0, v246
    v_bfi_b32 v247, s93, 0, v247
    s_cbranch_vccnz L_miss_q
    s_xor_b32 s79, s79, 1
    s_cbranch_scc1 L_retry_q
    s_branch L_ok_q
L_slow_fu:
    v_accvgpr_read_b32 v30, a233
    buffer_store_dwordx4 a[228:231], v30, s[56:59], 0 offen sc1
    s_mov_b32 s90, 400000
L_miss_fu:
    s_mov_b32 s79, 0
    s_sleep 1
L_retry_fu:
    s_sub_u32 s90, s90, 1
    s_cbranch_scc1 L_ok_fu
    buffer_load_dwordx4 v[72:75], v42, s[56:59], 0 offen sc1
    s_mov_b32 s78, 34816
    buffer_load_dwordx4 v[76:79], v42, s[56:59], s78 offen sc1
    s_waitcnt vmcnt(0)
    v_xor_b32 v72, v32, v72
    v_xor_b32 v73, v32, v73
    v_xor_b32 v74, v32, v74
    v_xor_b32 v76, v32, v76
    v_xor_b32 v77, v32, v77
    v_xor_b32 v78, v32, v78
    v_or3_b32 v30, v72, v73, v74
    v_or3_b32 v30, v30, v76, v77
    v_or_b32 v30, v30, v78
    v_and_b32 v30, s91, v30
    v_cmp_ne_u32 vcc, 0, v30
    v_bfi_b32 v75, s91, 0, v75
    v_bfi_b32 v79, s91, 0, v79
    s_cbranch_vccnz L_miss_fu
    s_xor_b32 s79, s79, 1
    s_cbranch_scc1 L_retry_fu
    s_branch L_ok_fu
L_slow_ml:
    v_bfi_b32 v30, s92, v0, v34
    v_bfi_b32 v31, s92, v0, v35
    v_mov_b32 v32, s0
    v_mov_b32 v33, s86
    buffer_store_dwordx4 v[30:33], v37, s[56:59], 0 offen sc1
    s_mov_b32 s90, 400000
L_miss_ml:
    s_mov_b32 s79, 0
    s_sleep 1
L_retry_ml:
    s_sub_u32 s90, s90, 1
    s_cbranch_scc1 L_ok_ml
    s_lshl_b32 s78, s75, 8
    s_add_u32 s78, s78, 786432
    v_lshl_add_u32 v36, v29, 4, s78
    buffer_load_dwordx4 v[10:13], v36, s[56:59], 0 offen sc1
    s_waitcnt vmcnt(0)
    v_xor_b32 v10, v0, v10
    v_xor_b32 v11, v0, v11
    v_xor_b32 v12, s0, v12
    v_or_b32 v30, v10, v11
    v_and_b32 v30, s92, v30
    v_or_b32 v30, v30, v12
    v_cmp_ne_u32 vcc, 0, v30
    s_cbranch_vccnz L_miss_ml
    s_xor_b32 s79, s79, 1
    s_cbranch_scc1 L_retry_ml
    s_branch L_ok_ml
L_codeend:
.rept 64
    s_nop 0
.endr
.section .rodata,"a"
.p2align 6
.amdhsa_kernel parallel_sum__sliding_block_cached__glu_gated_swiglu__decode_kernel
  .amdhsa_next_free_vgpr 512
  .amdhsa_next_free_sgpr 102
  .amdhsa_accum_offset 256
  .amdhsa_group_segment_fixed_size 0
  .amdhsa_kernarg_size 96
  .amdhsa_user_sgpr_count 2
  .amdhsa_user_sgpr_kernarg_segment_ptr 1
  .amdhsa_system_sgpr_workgroup_id_x 1
  .amdhsa_float_denorm_mode_32 3
.end_amdhsa_kernel
```
